```python
import torch

def _softmax(x, axis=-1):
    return torch.softmax(x, dim=axis)
def _gelu(x):
    return torch.nn.functional.gelu(x, approximate="tanh")
def _silu(x):
    return torch.nn.functional.silu(x)
def _sigmoid(x):
    return torch.sigmoid(x)
def _layernorm(x, axis=-1, eps=1e-5):
    m = x.mean(dim=axis, keepdim=True)
    v = x.var(dim=axis, keepdim=True, unbiased=False)
    return (x - m) / torch.sqrt(v + eps)
def _scatter_add(tgt, idx, src, axis=0):
    return tgt.clone().index_add_(axis, idx, src)
def _segment_sum(src, seg, n):
    out = torch.zeros((n,) + src.shape[1:], dtype=src.dtype)
    return out.index_add_(0, seg, src)
def _pad(x, pw):
    flat = tuple(v for pair in reversed(pw) for v in pair)
    return torch.nn.functional.pad(x, flat)

kernel_name = 'parallel_sum__ssm_conv_h3__swiglu_ffn__prompt'

def setup_inputs():

    _w = (lambda a: (lambda t: t.to(torch.bfloat16) if t.is_floating_point() else t)(torch.as_tensor(a)))
    def _A_setup():
        B, S, D = 1, 2048, 640
        ks = 4
        return {
            "q": _w((lambda *s: torch.randn(*s, dtype=torch.bfloat16) * 0.05)(B, S, D)),
            "k": _w((lambda *s: torch.randn(*s, dtype=torch.bfloat16) * 0.8)(B, S, D)),
            "v": _w((lambda *s: torch.randn(*s, dtype=torch.bfloat16) * 0.4)(B, S, D)),
            "shift_k": _w((lambda *s: torch.randn(*s, dtype=torch.bfloat16) * 0.8)(D, ks) * 0.5),
            "ssm_k": _w((lambda *s: torch.randn(*s, dtype=torch.bfloat16) * 0.8)(D, S) * (1.0 / S ** 0.5)),
            "ssm_D": _w((lambda *s: torch.randn(*s, dtype=torch.bfloat16) * 0.4)(D)),
        }
    _A_in = _A_setup()

    def _B_setup():
        B, S, D, F = 1, 2048, 640, 1536
        return {
            "x": _w((lambda *s: torch.randn(*s, dtype=torch.bfloat16) * 0.05)(B, S, D)),
            "w_gate": _w((lambda *s: torch.randn(*s, dtype=torch.bfloat16) * 0.05)(D, F)),
            "w_up": _w((lambda *s: torch.randn(*s, dtype=torch.bfloat16) * 0.05)(D, F)),
            "w_down": _w((lambda *s: torch.randn(*s, dtype=torch.bfloat16) * 0.05)(F, D)),
        }
    _B_in = _B_setup()

    return {
        "A_q": _A_in["q"],
        "A_k": _A_in["k"],
        "A_v": _A_in["v"],
        "A_shift_k": _A_in["shift_k"],
        "A_ssm_k": _A_in["ssm_k"],
        "A_ssm_D": _A_in["ssm_D"],
        "B_x": _B_in["x"],
        "B_w_gate": _B_in["w_gate"],
        "B_w_up": _B_in["w_up"],
        "B_w_down": _B_in["w_down"],
    }

def reference(A_q, A_k, A_v, A_shift_k, A_ssm_k, A_ssm_D, B_x, B_w_gate, B_w_up, B_w_down):
    def _A_ref(q, k, v, shift_k, ssm_k, ssm_D):
        B, S, D = q.shape
        ks = shift_k.shape[-1]
        k_pad = _pad(k, ((0, 0), (ks - 1, 0), (0, 0)))
        k_shift = torch.zeros_like(k)
        for t in range(ks):
            k_shift = k_shift + k_pad[:, t:t + S, :] * shift_k[:, ks - 1 - t][None, None, :]
        kv = k_shift * v
        L = 2 * S
        kv_pad = _pad(kv, ((0, 0), (0, S), (0, 0)))
        kf_pad = _pad(ssm_k, ((0, 0), (0, S)))
        kv_f = (lambda x, axes=(-2,-1): torch.fft.rfft2(x.float(), dim=axes))(kv_pad[:, None, :, :], axes=(1, 2))
        kf_f = (lambda x, axes=(-2,-1): torch.fft.rfft2(x.float(), dim=axes))(kf_pad[:, None, :], axes=(1, 2))
        kf_f = (lambda x, *d: x.permute(*d))(kf_f, 1, 2, 0)
        y_f = kv_f * kf_f[None, :, :, :]
        y = (lambda x, s, axes=(-2,-1): torch.fft.irfft2(x, s=s, dim=axes).to(torch.bfloat16))(y_f, (1, L), axes=(1, 2))[:, 0, :S, :]
        y = y + kv * ssm_D[None, None, :]
        return q * y

    def _B_ref(x, w_gate, w_up, w_down):
        g = _silu(x @ w_gate)
        u = x @ w_up
        return (g * u) @ w_down

    x = A_q
    xn = _layernorm(x, axis=-1)
    return x + _A_ref(xn, A_k, A_v, A_shift_k, A_ssm_k, A_ssm_D) + _B_ref(xn, B_w_gate, B_w_up, B_w_down)
```

```asm
; @launch grid=(256,1,1) block=(512,1,1) lds=163840
.amdgcn_target "amdgcn-amd-amdhsa--gfx950"
.text
.globl parallel_sum__ssm_conv_h3__swiglu_ffn__prompt_kernel
.p2align 8
.type parallel_sum__ssm_conv_h3__swiglu_ffn__prompt_kernel,@function
parallel_sum__ssm_conv_h3__swiglu_ffn__prompt_kernel:
  s_cmp_ge_u32 s2, 256
  s_cbranch_scc1 L_end
  s_load_dwordx16 s[8:23], s[0:1], 0
  s_load_dwordx8 s[24:31], s[0:1], 64
  s_load_dwordx2 s[32:33], s[0:1], 96
  s_getpc_b64 s[44:45]
L_pc:
  s_lshr_b32 s46, s2, 3
  s_lshl_b32 s46, s46, 11
  v_lshlrev_b32 v2, 2, v0
  v_add_u32 v2, s46, v2
  v_and_b32 v1, 31, v0
  v_lshl_or_b32 v2, v1, 26, v2
  s_mov_b32 s46, L_code_end-L_pc
  s_mov_b32 s47, 0x20000
  buffer_load_dword v200, v2, s[44:47], 0 offen
  v_lshrrev_b32 v1, 6, v0
  v_and_b32 v0, 63, v0
  v_readfirstlane_b32 s60, v1
  s_and_b32 s61, s2, 7
  s_lshr_b32 s62, s2, 3
  s_mov_b32 s34, 0x3f803f80
  s_cmp_ge_u32 s62, 24
  s_cbranch_scc1 L_c_head
  s_lshr_b32 s76, s61, 2
  s_and_b32 s77, s61, 3
  s_and_b32 s78, s62, 3
  s_lshl2_add_u32 s64, s76, s78
  s_lshr_b32 s66, s62, 2
  s_mul_i32 s65, s77, 6
  s_add_u32 s65, s65, s66
  s_and_b32 s67, s77, 1
  s_lshr_b32 s68, s77, 1
  s_mul_i32 s68, s68, 5
  s_add_u32 s68, s68, s66
  s_and_b32 s69, s78, 1
  s_mul_i32 s69, s69, 5
  s_lshl1_add_u32 s69, s76, s69
  s_mov_b32 s4, s2
  s_mov_b32 s5, 20480
  s_cmp_lt_u32 s60, 4
  s_cbranch_scc1 L_phase_a
L_helper:
  s_setprio 3
  s_sub_u32 s70, s60, 4
  s_and_b32 s76, s70, 1
  s_mul_i32 s76, s76, 98304
  s_lshl_b32 s77, s65, 7
  s_add_u32 s76, s76, s77
  s_and_b32 s77, s70, 2
  s_lshl_b32 s78, s64, 5
  s_add_u32 s78, s78, s70
  s_mul_i32 s78, s78, 10240
  s_lshl_b32 s79, s70, 2
  s_lshl_b32 s4, s70, 10
  s_lshl_b32 s5, s70, 12
  s_lshl_b32 s80, s69, 7
  v_lshrrev_b32 v26, 3, v0
  v_and_b32 v27, 7, v0
  v_lshrrev_b32 v28, 4, v0
  v_and_b32 v25, 1, v28
  v_lshl_or_b32 v25, v25, 2, s77
  v_xor_b32 v25, v25, v27
  v_mul_u32_u24 v2, 3072, v26
  v_lshl_add_u32 v2, v25, 4, v2
  v_add_u32 v2, s76, v2
  v_add_u32 v25, s79, v28
  v_and_b32 v25, 7, v25
  v_xor_b32 v25, v25, v27
  v_mul_u32_u24 v1, 1280, v26
  v_lshl_add_u32 v1, v25, 4, v1
  v_add_u32 v1, s78, v1
  v_add_u32 v24, 40960, v1
  s_waitcnt lgkmcnt(0)
  s_cmp_lg_u32 s77, 0
  s_cselect_b32 s44, s24, s22
  s_cselect_b32 s45, s25, s23
  s_mov_b32 s46, 1966080
  s_mov_b32 s47, 0x20000
  s_mov_b32 s40, s8
  s_mov_b32 s41, s9
  s_mov_b32 s42, 2621440
  s_mov_b32 s43, 0x20000
  s_add_u32 m0, s4, 0
  s_nop 0
  buffer_load_dwordx4 v1, s[40:43], s80 offen  lds
  s_add_u32 m0, s4, 40960
  s_nop 0
  buffer_load_dwordx4 v24, s[40:43], s80 offen  lds
  s_mul_i32 s6, s80, 1536
  s_add_u32 m0, s5, 122880
  s_add_u32 s76, s6, 0
  buffer_load_dwordx4 v2, s[44:47], s76 offen  lds
  s_add_u32 m0, s5, 123904
  s_add_u32 s76, s6, 24576
  buffer_load_dwordx4 v2, s[44:47], s76 offen  lds
  s_add_u32 m0, s5, 124928
  s_add_u32 s76, s6, 49152
  buffer_load_dwordx4 v2, s[44:47], s76 offen  lds
  s_add_u32 m0, s5, 125952
  s_add_u32 s76, s6, 73728
  buffer_load_dwordx4 v2, s[44:47], s76 offen  lds
  s_waitcnt lgkmcnt(0)
  s_load_dword s63, s[32:33], 0
  s_mov_b32 s36, s32
  s_mov_b32 s37, s33
  s_mov_b32 s38, 14680064
  s_mov_b32 s39, 0x20000
  s_add_u32 s81, s80, 128
  s_cmp_ge_u32 s81, 1280
  s_cselect_b32 s81, 0, s81
  s_add_u32 m0, s4, 4096
  s_nop 0
  buffer_load_dwordx4 v1, s[40:43], s81 offen  lds
  s_add_u32 m0, s4, 45056
  s_nop 0
  buffer_load_dwordx4 v24, s[40:43], s81 offen  lds
  s_mul_i32 s6, s81, 1536
  s_add_u32 m0, s5, 139264
  s_add_u32 s76, s6, 0
  buffer_load_dwordx4 v2, s[44:47], s76 offen  lds
  s_add_u32 m0, s5, 140288
  s_add_u32 s76, s6, 24576
  buffer_load_dwordx4 v2, s[44:47], s76 offen  lds
  s_add_u32 m0, s5, 141312
  s_add_u32 s76, s6, 49152
  buffer_load_dwordx4 v2, s[44:47], s76 offen  lds
  s_add_u32 m0, s5, 142336
  s_add_u32 s76, s6, 73728
  buffer_load_dwordx4 v2, s[44:47], s76 offen  lds
  v_lshlrev_b32 v3, 4, v0
  s_lshl2_add_u32 s76, s64, s70
  s_lshl_b32 s76, s76, 11
  s_add_u32 s35, s76, 12845056
  v_add_u32 v6, s4, v3
  v_add_u32 v6, 155648, v6
  v_bfe_u32 v4, v0, 2, 4
  v_lshlrev_b32 v4, 7, v4
  v_and_b32 v5, 3, v0
  v_lshlrev_b32 v5, 4, v5
  v_add_u32 v4, v4, v5
  s_waitcnt lgkmcnt(0)
  s_add_u32 s63, s63, 1
  s_barrier
  s_setprio 0
  s_add_u32 s82, s81, 128
  s_cmp_ge_u32 s82, 1280
  s_cselect_b32 s82, 0, s82
  s_add_u32 m0, s4, 8192
  s_nop 0
  buffer_load_dwordx4 v1, s[40:43], s82 offen  lds
  s_add_u32 m0, s4, 49152
  s_nop 0
  buffer_load_dwordx4 v24, s[40:43], s82 offen  lds
  s_mul_i32 s6, s82, 1536
  s_add_u32 m0, s5, 81920
  s_add_u32 s76, s6, 0
  buffer_load_dwordx4 v2, s[44:47], s76 offen  lds
  s_add_u32 m0, s5, 82944
  s_add_u32 s76, s6, 24576
  buffer_load_dwordx4 v2, s[44:47], s76 offen  lds
  s_add_u32 m0, s5, 83968
  s_add_u32 s76, s6, 49152
  buffer_load_dwordx4 v2, s[44:47], s76 offen  lds
  s_add_u32 m0, s5, 84992
  s_add_u32 s76, s6, 73728
  buffer_load_dwordx4 v2, s[44:47], s76 offen  lds
  s_waitcnt vmcnt(12)
  s_barrier
  s_add_u32 s83, s82, 128
  s_cmp_ge_u32 s83, 1280
  s_cselect_b32 s83, 0, s83
  s_add_u32 m0, s4, 12288
  s_nop 0
  buffer_load_dwordx4 v1, s[40:43], s83 offen  lds
  s_add_u32 m0, s4, 53248
  s_nop 0
  buffer_load_dwordx4 v24, s[40:43], s83 offen  lds
  s_mul_i32 s6, s83, 1536
  s_add_u32 m0, s5, 98304
  s_add_u32 s76, s6, 0
  buffer_load_dwordx4 v2, s[44:47], s76 offen  lds
  s_add_u32 m0, s5, 99328
  s_add_u32 s76, s6, 24576
  buffer_load_dwordx4 v2, s[44:47], s76 offen  lds
  s_add_u32 m0, s5, 100352
  s_add_u32 s76, s6, 49152
  buffer_load_dwordx4 v2, s[44:47], s76 offen  lds
  s_add_u32 m0, s5, 101376
  s_add_u32 s76, s6, 73728
  buffer_load_dwordx4 v2, s[44:47], s76 offen  lds
  s_waitcnt vmcnt(12)
  s_barrier
  s_add_u32 s84, s83, 128
  s_cmp_ge_u32 s84, 1280
  s_cselect_b32 s84, 0, s84
  s_add_u32 m0, s4, 16384
  s_nop 0
  buffer_load_dwordx4 v1, s[40:43], s84 offen  lds
  s_add_u32 m0, s4, 57344
  s_nop 0
  buffer_load_dwordx4 v24, s[40:43], s84 offen  lds
  s_mul_i32 s6, s84, 1536
  s_add_u32 m0, s5, 122880
  s_add_u32 s76, s6, 0
  buffer_load_dwordx4 v2, s[44:47], s76 offen  lds
  s_add_u32 m0, s5, 123904
  s_add_u32 s76, s6, 24576
  buffer_load_dwordx4 v2, s[44:47], s76 offen  lds
  s_add_u32 m0, s5, 124928
  s_add_u32 s76, s6, 49152
  buffer_load_dwordx4 v2, s[44:47], s76 offen  lds
  s_add_u32 m0, s5, 125952
  s_add_u32 s76, s6, 73728
  buffer_load_dwordx4 v2, s[44:47], s76 offen  lds
  s_waitcnt vmcnt(12)
  s_barrier
  s_add_u32 s85, s84, 128
  s_cmp_ge_u32 s85, 1280
  s_cselect_b32 s85, 0, s85
  s_add_u32 m0, s4, 20480
  s_nop 0
  buffer_load_dwordx4 v1, s[40:43], s85 offen  lds
  s_add_u32 m0, s4, 61440
  s_nop 0
  buffer_load_dwordx4 v24, s[40:43], s85 offen  lds
  s_mul_i32 s6, s85, 1536
  s_add_u32 m0, s5, 139264
  s_add_u32 s76, s6, 0
  buffer_load_dwordx4 v2, s[44:47], s76 offen  lds
  s_add_u32 m0, s5, 140288
  s_add_u32 s76, s6, 24576
  buffer_load_dwordx4 v2, s[44:47], s76 offen  lds
  s_add_u32 m0, s5, 141312
  s_add_u32 s76, s6, 49152
  buffer_load_dwordx4 v2, s[44:47], s76 offen  lds
  s_add_u32 m0, s5, 142336
  s_add_u32 s76, s6, 73728
  buffer_load_dwordx4 v2, s[44:47], s76 offen  lds
  s_waitcnt vmcnt(12)
  s_barrier
  s_add_u32 s86, s85, 128
  s_cmp_ge_u32 s86, 1280
  s_cselect_b32 s86, 0, s86
  s_add_u32 m0, s4, 24576
  s_nop 0
  buffer_load_dwordx4 v1, s[40:43], s86 offen  lds
  s_add_u32 m0, s4, 65536
  s_nop 0
  buffer_load_dwordx4 v24, s[40:43], s86 offen  lds
  s_mul_i32 s6, s86, 1536
  s_add_u32 m0, s5, 81920
  s_add_u32 s76, s6, 0
  buffer_load_dwordx4 v2, s[44:47], s76 offen  lds
  s_add_u32 m0, s5, 82944
  s_add_u32 s76, s6, 24576
  buffer_load_dwordx4 v2, s[44:47], s76 offen  lds
  s_add_u32 m0, s5, 83968
  s_add_u32 s76, s6, 49152
  buffer_load_dwordx4 v2, s[44:47], s76 offen  lds
  s_add_u32 m0, s5, 84992
  s_add_u32 s76, s6, 73728
  buffer_load_dwordx4 v2, s[44:47], s76 offen  lds
  s_waitcnt vmcnt(12)
  s_barrier
  s_add_u32 s87, s86, 128
  s_cmp_ge_u32 s87, 1280
  s_cselect_b32 s87, 0, s87
  s_add_u32 m0, s4, 28672
  s_nop 0
  buffer_load_dwordx4 v1, s[40:43], s87 offen  lds
  s_add_u32 m0, s4, 69632
  s_nop 0
  buffer_load_dwordx4 v24, s[40:43], s87 offen  lds
  s_mul_i32 s6, s87, 1536
  s_add_u32 m0, s5, 98304
  s_add_u32 s76, s6, 0
  buffer_load_dwordx4 v2, s[44:47], s76 offen  lds
  s_add_u32 m0, s5, 99328
  s_add_u32 s76, s6, 24576
  buffer_load_dwordx4 v2, s[44:47], s76 offen  lds
  s_add_u32 m0, s5, 100352
  s_add_u32 s76, s6, 49152
  buffer_load_dwordx4 v2, s[44:47], s76 offen  lds
  s_add_u32 m0, s5, 101376
  s_add_u32 s76, s6, 73728
  buffer_load_dwordx4 v2, s[44:47], s76 offen  lds
  s_waitcnt vmcnt(12)
  s_barrier
  s_add_u32 s88, s87, 128
  s_cmp_ge_u32 s88, 1280
  s_cselect_b32 s88, 0, s88
  s_add_u32 m0, s4, 32768
  s_nop 0
  buffer_load_dwordx4 v1, s[40:43], s88 offen  lds
  s_add_u32 m0, s4, 73728
  s_nop 0
  buffer_load_dwordx4 v24, s[40:43], s88 offen  lds
  s_mul_i32 s6, s88, 1536
  s_add_u32 m0, s5, 122880
  s_add_u32 s76, s6, 0
  buffer_load_dwordx4 v2, s[44:47], s76 offen  lds
  s_add_u32 m0, s5, 123904
  s_add_u32 s76, s6, 24576
  buffer_load_dwordx4 v2, s[44:47], s76 offen  lds
  s_add_u32 m0, s5, 124928
  s_add_u32 s76, s6, 49152
  buffer_load_dwordx4 v2, s[44:47], s76 offen  lds
  s_add_u32 m0, s5, 125952
  s_add_u32 s76, s6, 73728
  buffer_load_dwordx4 v2, s[44:47], s76 offen  lds
  s_waitcnt vmcnt(12)
  s_barrier
  s_add_u32 s89, s88, 128
  s_cmp_ge_u32 s89, 1280
  s_cselect_b32 s89, 0, s89
  s_add_u32 m0, s4, 36864
  s_nop 0
  buffer_load_dwordx4 v1, s[40:43], s89 offen  lds
  s_add_u32 m0, s4, 77824
  s_nop 0
  buffer_load_dwordx4 v24, s[40:43], s89 offen  lds
  s_mul_i32 s6, s89, 1536
  s_add_u32 m0, s5, 139264
  s_add_u32 s76, s6, 0
  buffer_load_dwordx4 v2, s[44:47], s76 offen  lds
  s_add_u32 m0, s5, 140288
  s_add_u32 s76, s6, 24576
  buffer_load_dwordx4 v2, s[44:47], s76 offen  lds
  s_add_u32 m0, s5, 141312
  s_add_u32 s76, s6, 49152
  buffer_load_dwordx4 v2, s[44:47], s76 offen  lds
  s_add_u32 m0, s5, 142336
  s_add_u32 s76, s6, 73728
  buffer_load_dwordx4 v2, s[44:47], s76 offen  lds
  s_waitcnt vmcnt(12)
  s_barrier
  s_waitcnt vmcnt(6)
  s_barrier
  v_add_u32 v24, 40960, v24
  s_add_u32 m0, s4, 81920
  s_nop 0
  buffer_load_dwordx4 v24, s[40:43], s80 offen  lds
  s_add_u32 m0, s4, 86016
  s_nop 0
  buffer_load_dwordx4 v24, s[40:43], s81 offen  lds
  s_add_u32 m0, s4, 90112
  s_nop 0
  buffer_load_dwordx4 v24, s[40:43], s82 offen  lds
  s_add_u32 m0, s4, 94208
  s_nop 0
  buffer_load_dwordx4 v24, s[40:43], s83 offen  lds
  s_add_u32 m0, s4, 98304
  s_nop 0
  buffer_load_dwordx4 v24, s[40:43], s84 offen  lds
  s_add_u32 m0, s4, 102400
  s_nop 0
  buffer_load_dwordx4 v24, s[40:43], s85 offen  lds
  s_add_u32 m0, s4, 106496
  s_nop 0
  buffer_load_dwordx4 v24, s[40:43], s86 offen  lds
  s_add_u32 m0, s4, 110592
  s_nop 0
  buffer_load_dwordx4 v24, s[40:43], s87 offen  lds
  s_add_u32 m0, s4, 114688
  s_nop 0
  buffer_load_dwordx4 v24, s[40:43], s88 offen  lds
  s_add_u32 m0, s4, 118784
  s_nop 0
  buffer_load_dwordx4 v24, s[40:43], s89 offen  lds
  s_waitcnt vmcnt(10)
  s_barrier
  buffer_load_dwordx4 v[16:19], v4, s[36:39], s35 offen sc1
  s_mov_b32 s44, s26
  s_mov_b32 s45, s27
  s_mov_b32 s46, 1966080
  s_mov_b32 s47, 0x20000
  s_mov_b32 s69, 0
  s_mul_i32 s76, s70, 491520
  s_lshl_b32 s77, s68, 7
  s_add_u32 s76, s76, s77
  v_lshlrev_b32 v25, 1, v28
  v_xor_b32 v25, v25, v27
  v_mul_u32_u24 v2, 1280, v26
  v_lshl_add_u32 v2, v25, 4, v2
  v_add_u32 v2, s76, v2
  s_lshl_b32 s5, s70, 13
  s_add_u32 s5, s5, 122880
  v_bfe_u32 v8, v0, 5, 1
  v_lshlrev_b32 v8, 11, v8
  v_bfe_u32 v25, v0, 4, 1
  v_mul_u32_u24 v25, 576, v25
  v_add_u32 v8, v8, v25
  v_bfe_u32 v25, v0, 2, 2
  v_lshlrev_b32 v25, 7, v25
  v_add_u32 v8, v8, v25
  v_bfe_u32 v25, v0, 3, 1
  v_lshlrev_b32 v25, 5, v25
  v_add_u32 v8, v8, v25
  v_and_b32 v25, 3, v0
  v_lshlrev_b32 v25, 3, v25
  v_add_u32 v8, v8, v25
  v_add_u32 v8, s5, v8
  v_xor_b32 v9, 32, v8
  v_xor_b32 v10, 64, v8
  v_xor_b32 v11, 96, v8
  s_waitcnt vmcnt(0)
  s_mov_b32 s71, 0
  s_branch L_chk_2
L_poll_1:
  buffer_load_dwordx4 v[16:19], v4, s[36:39], s35 offen sc1
  s_add_u32 s71, s71, 1
  s_cmp_ge_u32 s71, 200000
  s_waitcnt vmcnt(0)
  s_cbranch_scc1 L_ready_3
L_chk_2:
  v_cmp_ne_u32 vcc, s63, v17
  s_nop 1
  s_cbranch_vccnz L_poll_1
L_ready_3:
  ds_write_b128 v6, v[16:19]
  s_waitcnt lgkmcnt(0)
  s_barrier
  s_cmp_ge_u32 s66, 5
  s_cbranch_scc1 L_g1c
  v_add_u32 v24, 40960, v24
  s_add_u32 m0, s4, 0
  s_nop 0
  buffer_load_dwordx4 v24, s[40:43], s80 offen  lds
  s_add_u32 m0, s4, 4096
  s_nop 0
  buffer_load_dwordx4 v24, s[40:43], s81 offen  lds
  s_add_u32 m0, s4, 8192
  s_nop 0
  buffer_load_dwordx4 v24, s[40:43], s82 offen  lds
  s_add_u32 m0, s4, 12288
  s_nop 0
  buffer_load_dwordx4 v24, s[40:43], s83 offen  lds
  s_add_u32 m0, s4, 16384
  s_nop 0
  buffer_load_dwordx4 v24, s[40:43], s84 offen  lds
  s_add_u32 m0, s4, 20480
  s_nop 0
  buffer_load_dwordx4 v24, s[40:43], s85 offen  lds
  s_add_u32 m0, s4, 24576
  s_nop 0
  buffer_load_dwordx4 v24, s[40:43], s86 offen  lds
  s_add_u32 m0, s4, 28672
  s_nop 0
  buffer_load_dwordx4 v24, s[40:43], s87 offen  lds
  s_add_u32 m0, s4, 32768
  s_nop 0
  buffer_load_dwordx4 v24, s[40:43], s88 offen  lds
  s_add_u32 m0, s4, 36864
  s_nop 0
  buffer_load_dwordx4 v24, s[40:43], s89 offen  lds
  s_add_u32 s6, s69, 0
  s_sub_u32 s79, s6, 6
  s_cmp_ge_u32 s6, 6
  s_cselect_b32 s6, s79, s6
  s_mul_i32 s6, s6, 81920
  s_add_u32 m0, s5, 0
  s_add_u32 s76, s6, 0
  buffer_load_dwordx4 v2, s[44:47], s76 offen  lds
  s_add_u32 m0, s5, 1024
  s_add_u32 s76, s6, 10240
  buffer_load_dwordx4 v2, s[44:47], s76 offen  lds
  s_add_u32 m0, s5, 2048
  s_add_u32 s76, s6, 20480
  buffer_load_dwordx4 v2, s[44:47], s76 offen  lds
  s_add_u32 m0, s5, 3072
  s_add_u32 s76, s6, 30720
  buffer_load_dwordx4 v2, s[44:47], s76 offen  lds
  s_add_u32 m0, s5, 4096
  s_add_u32 s76, s6, 40960
  buffer_load_dwordx4 v2, s[44:47], s76 offen  lds
  s_add_u32 m0, s5, 5120
  s_add_u32 s76, s6, 51200
  buffer_load_dwordx4 v2, s[44:47], s76 offen  lds
  s_add_u32 m0, s5, 6144
  s_add_u32 s76, s6, 61440
  buffer_load_dwordx4 v2, s[44:47], s76 offen  lds
  s_add_u32 m0, s5, 7168
  s_add_u32 s76, s6, 71680
  buffer_load_dwordx4 v2, s[44:47], s76 offen  lds
  s_waitcnt vmcnt(8)
  s_barrier
  v_add_u32 v24, 40960, v24
  s_add_u32 m0, s4, 40960
  s_nop 0
  buffer_load_dwordx4 v24, s[40:43], s80 offen  lds
  s_add_u32 m0, s4, 45056
  s_nop 0
  buffer_load_dwordx4 v24, s[40:43], s81 offen  lds
  s_add_u32 m0, s4, 49152
  s_nop 0
  buffer_load_dwordx4 v24, s[40:43], s82 offen  lds
  s_add_u32 m0, s4, 53248
  s_nop 0
  buffer_load_dwordx4 v24, s[40:43], s83 offen  lds
  s_add_u32 m0, s4, 57344
  s_nop 0
  buffer_load_dwordx4 v24, s[40:43], s84 offen  lds
  s_add_u32 m0, s4, 61440
  s_nop 0
  buffer_load_dwordx4 v24, s[40:43], s85 offen  lds
  s_add_u32 m0, s4, 65536
  s_nop 0
  buffer_load_dwordx4 v24, s[40:43], s86 offen  lds
  s_add_u32 m0, s4, 69632
  s_nop 0
  buffer_load_dwordx4 v24, s[40:43], s87 offen  lds
  s_add_u32 m0, s4, 73728
  s_nop 0
  buffer_load_dwordx4 v24, s[40:43], s88 offen  lds
  s_add_u32 m0, s4, 77824
  s_nop 0
  buffer_load_dwordx4 v24, s[40:43], s89 offen  lds
  s_waitcnt vmcnt(10)
  ds_read_b64_tr_b16 v[64:65], v8 offset:0
  ds_read_b64_tr_b16 v[66:67], v8 offset:1024
  ds_read_b64_tr_b16 v[68:69], v9 offset:0
  ds_read_b64_tr_b16 v[70:71], v9 offset:1024
  ds_read_b64_tr_b16 v[72:73], v10 offset:0
  ds_read_b64_tr_b16 v[74:75], v10 offset:1024
  ds_read_b64_tr_b16 v[76:77], v11 offset:0
  ds_read_b64_tr_b16 v[78:79], v11 offset:1024
  s_waitcnt lgkmcnt(4)
  ds_read_b64_tr_b16 v[80:81], v8 offset:4096
  ds_read_b64_tr_b16 v[82:83], v8 offset:5120
  ds_read_b64_tr_b16 v[84:85], v9 offset:4096
  ds_read_b64_tr_b16 v[86:87], v9 offset:5120
  ds_read_b64_tr_b16 v[88:89], v10 offset:4096
  ds_read_b64_tr_b16 v[90:91], v10 offset:5120
  ds_read_b64_tr_b16 v[92:93], v11 offset:4096
  ds_read_b64_tr_b16 v[94:95], v11 offset:5120
  s_waitcnt lgkmcnt(0)
  s_add_u32 s6, s69, 1
  s_sub_u32 s79, s6, 6
  s_cmp_ge_u32 s6, 6
  s_cselect_b32 s6, s79, s6
  s_mul_i32 s6, s6, 81920
  s_add_u32 m0, s5, 0
  s_add_u32 s76, s6, 0
  buffer_load_dwordx4 v2, s[44:47], s76 offen  lds
  s_add_u32 m0, s5, 1024
  s_add_u32 s76, s6, 10240
  buffer_load_dwordx4 v2, s[44:47], s76 offen  lds
  s_add_u32 m0, s5, 2048
  s_add_u32 s76, s6, 20480
  buffer_load_dwordx4 v2, s[44:47], s76 offen  lds
  s_add_u32 m0, s5, 3072
  s_add_u32 s76, s6, 30720
  buffer_load_dwordx4 v2, s[44:47], s76 offen  lds
  s_add_u32 m0, s5, 4096
  s_add_u32 s76, s6, 40960
  buffer_load_dwordx4 v2, s[44:47], s76 offen  lds
  s_add_u32 m0, s5, 5120
  s_add_u32 s76, s6, 51200
  buffer_load_dwordx4 v2, s[44:47], s76 offen  lds
  s_add_u32 m0, s5, 6144
  s_add_u32 s76, s6, 61440
  buffer_load_dwordx4 v2, s[44:47], s76 offen  lds
  s_add_u32 m0, s5, 7168
  s_add_u32 s76, s6, 71680
  buffer_load_dwordx4 v2, s[44:47], s76 offen  lds
  s_waitcnt vmcnt(8)
  s_barrier
  v_add_u32 v24, 40960, v24
  s_add_u32 m0, s4, 81920
  s_nop 0
  buffer_load_dwordx4 v24, s[40:43], s80 offen  lds
  s_add_u32 m0, s4, 86016
  s_nop 0
  buffer_load_dwordx4 v24, s[40:43], s81 offen  lds
  s_add_u32 m0, s4, 90112
  s_nop 0
  buffer_load_dwordx4 v24, s[40:43], s82 offen  lds
  s_add_u32 m0, s4, 94208
  s_nop 0
  buffer_load_dwordx4 v24, s[40:43], s83 offen  lds
  s_add_u32 m0, s4, 98304
  s_nop 0
  buffer_load_dwordx4 v24, s[40:43], s84 offen  lds
  s_add_u32 m0, s4, 102400
  s_nop 0
  buffer_load_dwordx4 v24, s[40:43], s85 offen  lds
  s_add_u32 m0, s4, 106496
  s_nop 0
  buffer_load_dwordx4 v24, s[40:43], s86 offen  lds
  s_add_u32 m0, s4, 110592
  s_nop 0
  buffer_load_dwordx4 v24, s[40:43], s87 offen  lds
  s_add_u32 m0, s4, 114688
  s_nop 0
  buffer_load_dwordx4 v24, s[40:43], s88 offen  lds
  s_add_u32 m0, s4, 118784
  s_nop 0
  buffer_load_dwordx4 v24, s[40:43], s89 offen  lds
  s_waitcnt vmcnt(10)
  ds_read_b64_tr_b16 v[96:97], v8 offset:0
  ds_read_b64_tr_b16 v[98:99], v8 offset:1024
  ds_read_b64_tr_b16 v[100:101], v9 offset:0
  ds_read_b64_tr_b16 v[102:103], v9 offset:1024
  ds_read_b64_tr_b16 v[104:105], v10 offset:0
  ds_read_b64_tr_b16 v[106:107], v10 offset:1024
  ds_read_b64_tr_b16 v[108:109], v11 offset:0
  ds_read_b64_tr_b16 v[110:111], v11 offset:1024
  s_waitcnt lgkmcnt(4)
  ds_read_b64_tr_b16 v[112:113], v8 offset:4096
  ds_read_b64_tr_b16 v[114:115], v8 offset:5120
  ds_read_b64_tr_b16 v[116:117], v9 offset:4096
  ds_read_b64_tr_b16 v[118:119], v9 offset:5120
  ds_read_b64_tr_b16 v[120:121], v10 offset:4096
  ds_read_b64_tr_b16 v[122:123], v10 offset:5120
  ds_read_b64_tr_b16 v[124:125], v11 offset:4096
  ds_read_b64_tr_b16 v[126:127], v11 offset:5120
  s_waitcnt lgkmcnt(0)
  s_add_u32 s6, s69, 2
  s_sub_u32 s79, s6, 6
  s_cmp_ge_u32 s6, 6
  s_cselect_b32 s6, s79, s6
  s_mul_i32 s6, s6, 81920
  s_add_u32 m0, s5, 0
  s_add_u32 s76, s6, 0
  buffer_load_dwordx4 v2, s[44:47], s76 offen  lds
  s_add_u32 m0, s5, 1024
  s_add_u32 s76, s6, 10240
  buffer_load_dwordx4 v2, s[44:47], s76 offen  lds
  s_add_u32 m0, s5, 2048
  s_add_u32 s76, s6, 20480
  buffer_load_dwordx4 v2, s[44:47], s76 offen  lds
  s_add_u32 m0, s5, 3072
  s_add_u32 s76, s6, 30720
  buffer_load_dwordx4 v2, s[44:47], s76 offen  lds
  s_add_u32 m0, s5, 4096
  s_add_u32 s76, s6, 40960
  buffer_load_dwordx4 v2, s[44:47], s76 offen  lds
  s_add_u32 m0, s5, 5120
  s_add_u32 s76, s6, 51200
  buffer_load_dwordx4 v2, s[44:47], s76 offen  lds
  s_add_u32 m0, s5, 6144
  s_add_u32 s76, s6, 61440
  buffer_load_dwordx4 v2, s[44:47], s76 offen  lds
  s_add_u32 m0, s5, 7168
  s_add_u32 s76, s6, 71680
  buffer_load_dwordx4 v2, s[44:47], s76 offen  lds
  s_waitcnt vmcnt(8)
  s_barrier
  v_add_u32 v24, 40960, v24
  s_add_u32 m0, s4, 0
  s_nop 0
  buffer_load_dwordx4 v24, s[40:43], s80 offen  lds
  s_add_u32 m0, s4, 4096
  s_nop 0
  buffer_load_dwordx4 v24, s[40:43], s81 offen  lds
  s_add_u32 m0, s4, 8192
  s_nop 0
  buffer_load_dwordx4 v24, s[40:43], s82 offen  lds
  s_add_u32 m0, s4, 12288
  s_nop 0
  buffer_load_dwordx4 v24, s[40:43], s83 offen  lds
  s_add_u32 m0, s4, 16384
  s_nop 0
  buffer_load_dwordx4 v24, s[40:43], s84 offen  lds
  s_add_u32 m0, s4, 20480
  s_nop 0
  buffer_load_dwordx4 v24, s[40:43], s85 offen  lds
  s_add_u32 m0, s4, 24576
  s_nop 0
  buffer_load_dwordx4 v24, s[40:43], s86 offen  lds
  s_add_u32 m0, s4, 28672
  s_nop 0
  buffer_load_dwordx4 v24, s[40:43], s87 offen  lds
  s_add_u32 m0, s4, 32768
  s_nop 0
  buffer_load_dwordx4 v24, s[40:43], s88 offen  lds
  s_add_u32 m0, s4, 36864
  s_nop 0
  buffer_load_dwordx4 v24, s[40:43], s89 offen  lds
  s_waitcnt vmcnt(10)
  ds_read_b64_tr_b16 v[128:129], v8 offset:0
  ds_read_b64_tr_b16 v[130:131], v8 offset:1024
  ds_read_b64_tr_b16 v[132:133], v9 offset:0
  ds_read_b64_tr_b16 v[134:135], v9 offset:1024
  ds_read_b64_tr_b16 v[136:137], v10 offset:0
  ds_read_b64_tr_b16 v[138:139], v10 offset:1024
  ds_read_b64_tr_b16 v[140:141], v11 offset:0
  ds_read_b64_tr_b16 v[142:143], v11 offset:1024
  s_waitcnt lgkmcnt(4)
  ds_read_b64_tr_b16 v[144:145], v8 offset:4096
  ds_read_b64_tr_b16 v[146:147], v8 offset:5120
  ds_read_b64_tr_b16 v[148:149], v9 offset:4096
  ds_read_b64_tr_b16 v[150:151], v9 offset:5120
  ds_read_b64_tr_b16 v[152:153], v10 offset:4096
  ds_read_b64_tr_b16 v[154:155], v10 offset:5120
  ds_read_b64_tr_b16 v[156:157], v11 offset:4096
  ds_read_b64_tr_b16 v[158:159], v11 offset:5120
  s_waitcnt lgkmcnt(0)
  s_add_u32 s6, s69, 3
  s_sub_u32 s79, s6, 6
  s_cmp_ge_u32 s6, 6
  s_cselect_b32 s6, s79, s6
  s_mul_i32 s6, s6, 81920
  s_add_u32 m0, s5, 0
  s_add_u32 s76, s6, 0
  buffer_load_dwordx4 v2, s[44:47], s76 offen  lds
  s_add_u32 m0, s5, 1024
  s_add_u32 s76, s6, 10240
  buffer_load_dwordx4 v2, s[44:47], s76 offen  lds
  s_add_u32 m0, s5, 2048
  s_add_u32 s76, s6, 20480
  buffer_load_dwordx4 v2, s[44:47], s76 offen  lds
  s_add_u32 m0, s5, 3072
  s_add_u32 s76, s6, 30720
  buffer_load_dwordx4 v2, s[44:47], s76 offen  lds
  s_add_u32 m0, s5, 4096
  s_add_u32 s76, s6, 40960
  buffer_load_dwordx4 v2, s[44:47], s76 offen  lds
  s_add_u32 m0, s5, 5120
  s_add_u32 s76, s6, 51200
  buffer_load_dwordx4 v2, s[44:47], s76 offen  lds
  s_add_u32 m0, s5, 6144
  s_add_u32 s76, s6, 61440
  buffer_load_dwordx4 v2, s[44:47], s76 offen  lds
  s_add_u32 m0, s5, 7168
  s_add_u32 s76, s6, 71680
  buffer_load_dwordx4 v2, s[44:47], s76 offen  lds
  s_waitcnt vmcnt(8)
  s_barrier
  v_add_u32 v24, 40960, v24
  s_add_u32 m0, s4, 40960
  s_nop 0
  buffer_load_dwordx4 v24, s[40:43], s80 offen  lds
  s_add_u32 m0, s4, 45056
  s_nop 0
  buffer_load_dwordx4 v24, s[40:43], s81 offen  lds
  s_add_u32 m0, s4, 49152
  s_nop 0
  buffer_load_dwordx4 v24, s[40:43], s82 offen  lds
  s_add_u32 m0, s4, 53248
  s_nop 0
  buffer_load_dwordx4 v24, s[40:43], s83 offen  lds
  s_add_u32 m0, s4, 57344
  s_nop 0
  buffer_load_dwordx4 v24, s[40:43], s84 offen  lds
  s_add_u32 m0, s4, 61440
  s_nop 0
  buffer_load_dwordx4 v24, s[40:43], s85 offen  lds
  s_add_u32 m0, s4, 65536
  s_nop 0
  buffer_load_dwordx4 v24, s[40:43], s86 offen  lds
  s_add_u32 m0, s4, 69632
  s_nop 0
  buffer_load_dwordx4 v24, s[40:43], s87 offen  lds
  s_add_u32 m0, s4, 73728
  s_nop 0
  buffer_load_dwordx4 v24, s[40:43], s88 offen  lds
  s_add_u32 m0, s4, 77824
  s_nop 0
  buffer_load_dwordx4 v24, s[40:43], s89 offen  lds
  s_waitcnt vmcnt(10)
  ds_read_b64_tr_b16 v[160:161], v8 offset:0
  ds_read_b64_tr_b16 v[162:163], v8 offset:1024
  ds_read_b64_tr_b16 v[164:165], v9 offset:0
  ds_read_b64_tr_b16 v[166:167], v9 offset:1024
  ds_read_b64_tr_b16 v[168:169], v10 offset:0
  ds_read_b64_tr_b16 v[170:171], v10 offset:1024
  ds_read_b64_tr_b16 v[172:173], v11 offset:0
  ds_read_b64_tr_b16 v[174:175], v11 offset:1024
  s_waitcnt lgkmcnt(4)
  ds_read_b64_tr_b16 v[176:177], v8 offset:4096
  ds_read_b64_tr_b16 v[178:179], v8 offset:5120
  ds_read_b64_tr_b16 v[180:181], v9 offset:4096
  ds_read_b64_tr_b16 v[182:183], v9 offset:5120
  ds_read_b64_tr_b16 v[184:185], v10 offset:4096
  ds_read_b64_tr_b16 v[186:187], v10 offset:5120
  ds_read_b64_tr_b16 v[188:189], v11 offset:4096
  ds_read_b64_tr_b16 v[190:191], v11 offset:5120
  s_waitcnt lgkmcnt(0)
  s_add_u32 s6, s69, 4
  s_sub_u32 s79, s6, 6
  s_cmp_ge_u32 s6, 6
  s_cselect_b32 s6, s79, s6
  s_mul_i32 s6, s6, 81920
  s_add_u32 m0, s5, 0
  s_add_u32 s76, s6, 0
  buffer_load_dwordx4 v2, s[44:47], s76 offen  lds
  s_add_u32 m0, s5, 1024
  s_add_u32 s76, s6, 10240
  buffer_load_dwordx4 v2, s[44:47], s76 offen  lds
  s_add_u32 m0, s5, 2048
  s_add_u32 s76, s6, 20480
  buffer_load_dwordx4 v2, s[44:47], s76 offen  lds
  s_add_u32 m0, s5, 3072
  s_add_u32 s76, s6, 30720
  buffer_load_dwordx4 v2, s[44:47], s76 offen  lds
  s_add_u32 m0, s5, 4096
  s_add_u32 s76, s6, 40960
  buffer_load_dwordx4 v2, s[44:47], s76 offen  lds
  s_add_u32 m0, s5, 5120
  s_add_u32 s76, s6, 51200
  buffer_load_dwordx4 v2, s[44:47], s76 offen  lds
  s_add_u32 m0, s5, 6144
  s_add_u32 s76, s6, 61440
  buffer_load_dwordx4 v2, s[44:47], s76 offen  lds
  s_add_u32 m0, s5, 7168
  s_add_u32 s76, s6, 71680
  buffer_load_dwordx4 v2, s[44:47], s76 offen  lds
  s_waitcnt vmcnt(8)
  s_barrier
  s_add_u32 s6, s69, 5
  s_sub_u32 s79, s6, 6
  s_cmp_ge_u32 s6, 6
  s_cselect_b32 s6, s79, s6
  s_mul_i32 s6, s6, 81920
  s_sub_u32 s77, s5, 40960
  s_add_u32 m0, s77, 0
  s_add_u32 s76, s6, 0
  buffer_load_dwordx4 v2, s[44:47], s76 offen  lds
  s_add_u32 m0, s77, 1024
  s_add_u32 s76, s6, 10240
  buffer_load_dwordx4 v2, s[44:47], s76 offen  lds
  s_add_u32 m0, s77, 2048
  s_add_u32 s76, s6, 20480
  buffer_load_dwordx4 v2, s[44:47], s76 offen  lds
  s_add_u32 m0, s77, 3072
  s_add_u32 s76, s6, 30720
  buffer_load_dwordx4 v2, s[44:47], s76 offen  lds
  s_add_u32 m0, s77, 4096
  s_add_u32 s76, s6, 40960
  buffer_load_dwordx4 v2, s[44:47], s76 offen  lds
  s_add_u32 m0, s77, 5120
  s_add_u32 s76, s6, 51200
  buffer_load_dwordx4 v2, s[44:47], s76 offen  lds
  s_add_u32 m0, s77, 6144
  s_add_u32 s76, s6, 61440
  buffer_load_dwordx4 v2, s[44:47], s76 offen  lds
  s_add_u32 m0, s77, 7168
  s_add_u32 s76, s6, 71680
  buffer_load_dwordx4 v2, s[44:47], s76 offen  lds
  s_lshl3_add_u32 s76, s64, s67
  s_mul_i32 s4, s76, 96
  s_mul_i32 s77, s70, 12
  s_add_u32 s4, s4, s77
  s_lshl_b32 s4, s4, 10
  s_add_u32 s4, s4, 5767168
  s_mul_i32 s6, s64, 12
  s_add_u32 s6, s6, s70
  s_mul_i32 s6, s6, 768
  s_add_u32 s6, s6, 13631488
  s_load_dword s48, s[32:33], s6 offset:0
  s_load_dword s49, s[32:33], s6 offset:128
  s_load_dword s50, s[32:33], s6 offset:256
  s_load_dword s51, s[32:33], s6 offset:384
  s_load_dword s52, s[32:33], s6 offset:512
  s_load_dword s53, s[32:33], s6 offset:640
  s_lshl2_add_u32 s76, s68, s70
  s_lshl_b32 s56, s76, 10
  s_add_u32 s56, s56, 131072
  s_mul_i32 s76, s76, 67584
  s_lshl_b32 s78, s64, 9
  s_add_u32 s76, s76, s78
  s_lshl_b32 s78, s67, 8
  s_add_u32 s76, s76, s78
  s_add_u32 s76, s76, 3014656
  s_lshl_b32 s57, s70, 12
  v_mul_u32_u24 v26, 4224, v28
  v_add_u32 v26, s76, v26
  v_and_b32 v27, 15, v0
  v_xor_b32 v27, v27, v28
  s_lshl_b32 s78, s70, 1
  s_add_u32 s78, s78, 0
  s_and_b32 s78, s78, 3
  s_lshl_b32 s78, s78, 2
  v_xor_b32 v25, s78, v27
  v_lshl_add_u32 v4, v25, 4, v26
  s_lshl_b32 s78, s70, 1
  s_add_u32 s78, s78, 1
  s_and_b32 s78, s78, 3
  s_lshl_b32 s78, s78, 2
  v_xor_b32 v25, s78, v27
  v_lshl_add_u32 v5, v25, 4, v26
  s_add_u32 s80, s69, 0
  s_sub_u32 s79, s80, 6
  s_cmp_ge_u32 s80, 6
  s_cselect_b32 s80, s79, s80
  s_lshl_b32 s80, s80, 11
  s_add_u32 s80, s80, s4
  s_add_u32 s81, s69, 1
  s_sub_u32 s79, s81, 6
  s_cmp_ge_u32 s81, 6
  s_cselect_b32 s81, s79, s81
  s_lshl_b32 s81, s81, 11
  s_add_u32 s81, s81, s4
  s_add_u32 s82, s69, 2
  s_sub_u32 s79, s82, 6
  s_cmp_ge_u32 s82, 6
  s_cselect_b32 s82, s79, s82
  s_lshl_b32 s82, s82, 11
  s_add_u32 s82, s82, s4
  s_add_u32 s83, s69, 3
  s_sub_u32 s79, s83, 6
  s_cmp_ge_u32 s83, 6
  s_cselect_b32 s83, s79, s83
  s_lshl_b32 s83, s83, 11
  s_add_u32 s83, s83, s4
  s_add_u32 s84, s69, 4
  s_sub_u32 s79, s84, 6
  s_cmp_ge_u32 s84, 6
  s_cselect_b32 s84, s79, s84
  s_lshl_b32 s84, s84, 11
  s_add_u32 s84, s84, s4
  s_add_u32 s85, s69, 5
  s_sub_u32 s79, s85, 6
  s_cmp_ge_u32 s85, 6
  s_cselect_b32 s85, s79, s85
  s_lshl_b32 s85, s85, 11
  s_add_u32 s85, s85, s4
  s_mul_i32 s76, s70, 9216
  v_bfe_u32 v6, v0, 4, 1
  v_mul_u32_u24 v6, 4608, v6
  v_bfe_u32 v26, v0, 5, 1
  v_mul_u32_u24 v26, 576, v26
  v_add_u32 v6, v6, v26
  v_and_b32 v26, 15, v0
  v_lshlrev_b32 v26, 4, v26
  v_add_u32 v6, v6, v26
  v_add_u32 v6, s76, v6
  v_mov_b32 v0, v6
  v_mov_b32 v1, v4
  v_mov_b32 v2, v5
  s_mov_b32 s71, 0
L_spoll_4:
  s_waitcnt lgkmcnt(0)
  s_xor_b32 s48, s48, s63
  s_xor_b32 s49, s49, s63
  s_xor_b32 s50, s50, s63
  s_xor_b32 s51, s51, s63
  s_xor_b32 s52, s52, s63
  s_xor_b32 s53, s53, s63
  s_or_b32 s48, s48, s49
  s_or_b32 s48, s48, s50
  s_or_b32 s48, s48, s51
  s_or_b32 s48, s48, s52
  s_or_b32 s48, s48, s53
  s_cmp_eq_u32 s48, 0
  s_cbranch_scc1 L_sready_5
  s_add_u32 s71, s71, 1
  s_cmp_ge_u32 s71, 200000
  s_cbranch_scc1 L_sready_5
  s_load_dword s48, s[32:33], s6 offset:0 glc
  s_load_dword s49, s[32:33], s6 offset:128 glc
  s_load_dword s50, s[32:33], s6 offset:256 glc
  s_load_dword s51, s[32:33], s6 offset:384 glc
  s_load_dword s52, s[32:33], s6 offset:512 glc
  s_load_dword s53, s[32:33], s6 offset:640 glc
  s_branch L_spoll_4
L_sready_5:
  s_add_u32 s76, s80, 0
  buffer_load_dwordx4 v[16:19], v3, s[36:39], s76 offen offset:0 sc1
  buffer_load_dwordx4 v[20:23], v3, s[36:39], s76 offen offset:1024 sc1
  s_add_u32 s76, s81, 0
  buffer_load_dwordx4 v[24:27], v3, s[36:39], s76 offen offset:0 sc1
  buffer_load_dwordx4 v[28:31], v3, s[36:39], s76 offen offset:1024 sc1
  s_add_u32 s76, s82, 0
  buffer_load_dwordx4 v[32:35], v3, s[36:39], s76 offen offset:0 sc1
  buffer_load_dwordx4 v[36:39], v3, s[36:39], s76 offen offset:1024 sc1
  s_add_u32 s76, s83, 0
  buffer_load_dwordx4 v[40:43], v3, s[36:39], s76 offen offset:0 sc1
  buffer_load_dwordx4 v[44:47], v3, s[36:39], s76 offen offset:1024 sc1
  s_add_u32 s76, s84, 0
  buffer_load_dwordx4 v[12:15], v3, s[36:39], s76 offen offset:0 sc1
  buffer_load_dwordx4 v[4:7], v3, s[36:39], s76 offen offset:1024 sc1
  s_waitcnt vmcnt(18)
  ds_read_b64_tr_b16 v[192:193], v8 offset:0
  ds_read_b64_tr_b16 v[194:195], v8 offset:1024
  ds_read_b64_tr_b16 v[196:197], v9 offset:0
  ds_read_b64_tr_b16 v[198:199], v9 offset:1024
  ds_read_b64_tr_b16 v[200:201], v10 offset:0
  ds_read_b64_tr_b16 v[202:203], v10 offset:1024
  ds_read_b64_tr_b16 v[204:205], v11 offset:0
  ds_read_b64_tr_b16 v[206:207], v11 offset:1024
  s_waitcnt lgkmcnt(4)
  ds_read_b64_tr_b16 v[208:209], v8 offset:4096
  ds_read_b64_tr_b16 v[210:211], v8 offset:5120
  ds_read_b64_tr_b16 v[212:213], v9 offset:4096
  ds_read_b64_tr_b16 v[214:215], v9 offset:5120
  ds_read_b64_tr_b16 v[216:217], v10 offset:4096
  ds_read_b64_tr_b16 v[218:219], v10 offset:5120
  ds_read_b64_tr_b16 v[220:221], v11 offset:4096
  ds_read_b64_tr_b16 v[222:223], v11 offset:5120
  s_waitcnt lgkmcnt(0)
  s_waitcnt vmcnt(10)
  v_subrev_u32 v8, 40960, v8
  v_subrev_u32 v9, 40960, v9
  v_subrev_u32 v10, 40960, v10
  v_subrev_u32 v11, 40960, v11
  ds_read_b64_tr_b16 v[224:225], v8 offset:0
  ds_read_b64_tr_b16 v[226:227], v8 offset:1024
  ds_read_b64_tr_b16 v[228:229], v9 offset:0
  ds_read_b64_tr_b16 v[230:231], v9 offset:1024
  ds_read_b64_tr_b16 v[232:233], v10 offset:0
  ds_read_b64_tr_b16 v[234:235], v10 offset:1024
  ds_read_b64_tr_b16 v[236:237], v11 offset:0
  ds_read_b64_tr_b16 v[238:239], v11 offset:1024
  s_waitcnt lgkmcnt(4)
  ds_read_b64_tr_b16 v[240:241], v8 offset:4096
  ds_read_b64_tr_b16 v[242:243], v8 offset:5120
  ds_read_b64_tr_b16 v[244:245], v9 offset:4096
  ds_read_b64_tr_b16 v[246:247], v9 offset:5120
  ds_read_b64_tr_b16 v[248:249], v10 offset:4096
  ds_read_b64_tr_b16 v[250:251], v10 offset:5120
  ds_read_b64_tr_b16 v[252:253], v11 offset:4096
  ds_read_b64_tr_b16 v[254:255], v11 offset:5120
  s_waitcnt lgkmcnt(0)
  s_add_u32 s76, s85, 0
  buffer_load_dwordx4 v[8:11], v3, s[36:39], s76 offen offset:0 sc1
  s_setprio 0
  s_waitcnt vmcnt(10)
  v_mfma_f32_16x16x32_bf16 v[48:51], v[64:67], v[16:19], 0
  v_mfma_f32_16x16x32_bf16 v[52:55], v[68:71], v[16:19], 0
  v_mfma_f32_16x16x32_bf16 v[56:59], v[72:75], v[16:19], 0
  v_mfma_f32_16x16x32_bf16 v[60:63], v[76:79], v[16:19], 0
  s_waitcnt vmcnt(9)
  v_mfma_f32_16x16x32_bf16 v[48:51], v[80:83], v[20:23], v[48:51]
  buffer_load_dwordx4 v[16:19], v3, s[36:39], s76 offen offset:1024 sc1
  v_mfma_f32_16x16x32_bf16 v[52:55], v[84:87], v[20:23], v[52:55]
  v_mfma_f32_16x16x32_bf16 v[56:59], v[88:91], v[20:23], v[56:59]
  v_mfma_f32_16x16x32_bf16 v[60:63], v[92:95], v[20:23], v[60:63]
  s_waitcnt vmcnt(9)
  v_mfma_f32_16x16x32_bf16 v[48:51], v[96:99], v[24:27], v[48:51]
  s_add_u32 s76, s80, 49152
  buffer_load_dwordx4 v[20:23], v3, s[36:39], s76 offen offset:0 sc1
  v_mfma_f32_16x16x32_bf16 v[52:55], v[100:103], v[24:27], v[52:55]
  v_mfma_f32_16x16x32_bf16 v[56:59], v[104:107], v[24:27], v[56:59]
  v_mfma_f32_16x16x32_bf16 v[60:63], v[108:111], v[24:27], v[60:63]
  s_waitcnt vmcnt(9)
  v_mfma_f32_16x16x32_bf16 v[48:51], v[112:115], v[28:31], v[48:51]
  buffer_load_dwordx4 v[24:27], v3, s[36:39], s76 offen offset:1024 sc1
  v_mfma_f32_16x16x32_bf16 v[52:55], v[116:119], v[28:31], v[52:55]
  v_mfma_f32_16x16x32_bf16 v[56:59], v[120:123], v[28:31], v[56:59]
  v_mfma_f32_16x16x32_bf16 v[60:63], v[124:127], v[28:31], v[60:63]
  s_waitcnt vmcnt(9)
  v_mfma_f32_16x16x32_bf16 v[48:51], v[128:131], v[32:35], v[48:51]
  s_add_u32 s76, s81, 49152
  buffer_load_dwordx4 v[28:31], v3, s[36:39], s76 offen offset:0 sc1
  v_mfma_f32_16x16x32_bf16 v[52:55], v[132:135], v[32:35], v[52:55]
  v_mfma_f32_16x16x32_bf16 v[56:59], v[136:139], v[32:35], v[56:59]
  v_mfma_f32_16x16x32_bf16 v[60:63], v[140:143], v[32:35], v[60:63]
  s_waitcnt vmcnt(9)
  v_mfma_f32_16x16x32_bf16 v[48:51], v[144:147], v[36:39], v[48:51]
  buffer_load_dwordx4 v[32:35], v3, s[36:39], s76 offen offset:1024 sc1
  v_mfma_f32_16x16x32_bf16 v[52:55], v[148:151], v[36:39], v[52:55]
  v_mfma_f32_16x16x32_bf16 v[56:59], v[152:155], v[36:39], v[56:59]
  v_mfma_f32_16x16x32_bf16 v[60:63], v[156:159], v[36:39], v[60:63]
  s_waitcnt vmcnt(9)
  v_mfma_f32_16x16x32_bf16 v[48:51], v[160:163], v[40:43], v[48:51]
  s_add_u32 s76, s82, 49152
  buffer_load_dwordx4 v[36:39], v3, s[36:39], s76 offen offset:0 sc1
  v_mfma_f32_16x16x32_bf16 v[52:55], v[164:167], v[40:43], v[52:55]
  v_mfma_f32_16x16x32_bf16 v[56:59], v[168:171], v[40:43], v[56:59]
  v_mfma_f32_16x16x32_bf16 v[60:63], v[172:175], v[40:43], v[60:63]
  s_waitcnt vmcnt(9)
  v_mfma_f32_16x16x32_bf16 v[48:51], v[176:179], v[44:47], v[48:51]
  buffer_load_dwordx4 v[40:43], v3, s[36:39], s76 offen offset:1024 sc1
  v_mfma_f32_16x16x32_bf16 v[52:55], v[180:183], v[44:47], v[52:55]
  v_mfma_f32_16x16x32_bf16 v[56:59], v[184:187], v[44:47], v[56:59]
  v_mfma_f32_16x16x32_bf16 v[60:63], v[188:191], v[44:47], v[60:63]
  s_waitcnt vmcnt(9)
  v_mfma_f32_16x16x32_bf16 v[48:51], v[192:195], v[12:15], v[48:51]
  s_add_u32 s76, s83, 49152
  buffer_load_dwordx4 v[44:47], v3, s[36:39], s76 offen offset:0 sc1
  v_mfma_f32_16x16x32_bf16 v[52:55], v[196:199], v[12:15], v[52:55]
  v_mfma_f32_16x16x32_bf16 v[56:59], v[200:203], v[12:15], v[56:59]
  v_mfma_f32_16x16x32_bf16 v[60:63], v[204:207], v[12:15], v[60:63]
  s_waitcnt vmcnt(9)
  v_mfma_f32_16x16x32_bf16 v[48:51], v[208:211], v[4:7], v[48:51]
  buffer_load_dwordx4 v[12:15], v3, s[36:39], s76 offen offset:1024 sc1
  v_mfma_f32_16x16x32_bf16 v[52:55], v[212:215], v[4:7], v[52:55]
  v_mfma_f32_16x16x32_bf16 v[56:59], v[216:219], v[4:7], v[56:59]
  v_mfma_f32_16x16x32_bf16 v[60:63], v[220:223], v[4:7], v[60:63]
  s_waitcnt vmcnt(9)
  v_mfma_f32_16x16x32_bf16 v[48:51], v[224:227], v[8:11], v[48:51]
  s_add_u32 s76, s84, 49152
  buffer_load_dwordx4 v[4:7], v3, s[36:39], s76 offen offset:0 sc1
  v_mfma_f32_16x16x32_bf16 v[52:55], v[228:231], v[8:11], v[52:55]
  v_mfma_f32_16x16x32_bf16 v[56:59], v[232:235], v[8:11], v[56:59]
  v_mfma_f32_16x16x32_bf16 v[60:63], v[236:239], v[8:11], v[60:63]
  s_waitcnt vmcnt(9)
  v_mfma_f32_16x16x32_bf16 v[48:51], v[240:243], v[16:19], v[48:51]
  buffer_load_dwordx4 v[8:11], v3, s[36:39], s76 offen offset:1024 sc1
  v_mfma_f32_16x16x32_bf16 v[52:55], v[244:247], v[16:19], v[52:55]
  v_mfma_f32_16x16x32_bf16 v[56:59], v[248:251], v[16:19], v[56:59]
  v_mfma_f32_16x16x32_bf16 v[60:63], v[252:255], v[16:19], v[60:63]
  s_waitcnt vmcnt(9)
  s_nop 2
  ds_write_b128 v0, v[48:51] offset:0
  v_mfma_f32_16x16x32_bf16 v[48:51], v[64:67], v[20:23], 0
  s_add_u32 s76, s85, 49152
  buffer_load_dwordx4 v[16:19], v3, s[36:39], s76 offen offset:0 sc1
  ds_write_b128 v0, v[52:55] offset:1152
  v_mfma_f32_16x16x32_bf16 v[52:55], v[68:71], v[20:23], 0
  ds_write_b128 v0, v[56:59] offset:2304
  v_mfma_f32_16x16x32_bf16 v[56:59], v[72:75], v[20:23], 0
  ds_write_b128 v0, v[60:63] offset:3456
  v_mfma_f32_16x16x32_bf16 v[60:63], v[76:79], v[20:23], 0
  s_waitcnt vmcnt(9)
  v_mfma_f32_16x16x32_bf16 v[48:51], v[80:83], v[24:27], v[48:51]
  buffer_load_dwordx4 v[20:23], v3, s[36:39], s76 offen offset:1024 sc1
  v_mfma_f32_16x16x32_bf16 v[52:55], v[84:87], v[24:27], v[52:55]
  v_mfma_f32_16x16x32_bf16 v[56:59], v[88:91], v[24:27], v[56:59]
  v_mfma_f32_16x16x32_bf16 v[60:63], v[92:95], v[24:27], v[60:63]
  s_waitcnt vmcnt(9)
  v_mfma_f32_16x16x32_bf16 v[48:51], v[96:99], v[28:31], v[48:51]
  s_add_u32 s76, s80, 196608
  buffer_load_dwordx4 v[24:27], v3, s[36:39], s76 offen offset:0 sc1
  v_mfma_f32_16x16x32_bf16 v[52:55], v[100:103], v[28:31], v[52:55]
  v_mfma_f32_16x16x32_bf16 v[56:59], v[104:107], v[28:31], v[56:59]
  v_mfma_f32_16x16x32_bf16 v[60:63], v[108:111], v[28:31], v[60:63]
  s_waitcnt vmcnt(9)
  v_mfma_f32_16x16x32_bf16 v[48:51], v[112:115], v[32:35], v[48:51]
  buffer_load_dwordx4 v[28:31], v3, s[36:39], s76 offen offset:1024 sc1
  v_mfma_f32_16x16x32_bf16 v[52:55], v[116:119], v[32:35], v[52:55]
  v_mfma_f32_16x16x32_bf16 v[56:59], v[120:123], v[32:35], v[56:59]
  v_mfma_f32_16x16x32_bf16 v[60:63], v[124:127], v[32:35], v[60:63]
  s_waitcnt vmcnt(9)
  v_mfma_f32_16x16x32_bf16 v[48:51], v[128:131], v[36:39], v[48:51]
  s_add_u32 s76, s81, 196608
  buffer_load_dwordx4 v[32:35], v3, s[36:39], s76 offen offset:0 sc1
  v_mfma_f32_16x16x32_bf16 v[52:55], v[132:135], v[36:39], v[52:55]
  v_mfma_f32_16x16x32_bf16 v[56:59], v[136:139], v[36:39], v[56:59]
  v_mfma_f32_16x16x32_bf16 v[60:63], v[140:143], v[36:39], v[60:63]
  s_waitcnt vmcnt(9)
  v_mfma_f32_16x16x32_bf16 v[48:51], v[144:147], v[40:43], v[48:51]
  buffer_load_dwordx4 v[36:39], v3, s[36:39], s76 offen offset:1024 sc1
  v_mfma_f32_16x16x32_bf16 v[52:55], v[148:151], v[40:43], v[52:55]
  v_mfma_f32_16x16x32_bf16 v[56:59], v[152:155], v[40:43], v[56:59]
  v_mfma_f32_16x16x32_bf16 v[60:63], v[156:159], v[40:43], v[60:63]
  s_waitcnt vmcnt(9)
  v_mfma_f32_16x16x32_bf16 v[48:51], v[160:163], v[44:47], v[48:51]
  s_add_u32 s76, s82, 196608
  buffer_load_dwordx4 v[40:43], v3, s[36:39], s76 offen offset:0 sc1
  v_mfma_f32_16x16x32_bf16 v[52:55], v[164:167], v[44:47], v[52:55]
  v_mfma_f32_16x16x32_bf16 v[56:59], v[168:171], v[44:47], v[56:59]
  v_mfma_f32_16x16x32_bf16 v[60:63], v[172:175], v[44:47], v[60:63]
  s_waitcnt vmcnt(9)
  v_mfma_f32_16x16x32_bf16 v[48:51], v[176:179], v[12:15], v[48:51]
  buffer_load_dwordx4 v[44:47], v3, s[36:39], s76 offen offset:1024 sc1
  v_mfma_f32_16x16x32_bf16 v[52:55], v[180:183], v[12:15], v[52:55]
  v_mfma_f32_16x16x32_bf16 v[56:59], v[184:187], v[12:15], v[56:59]
  v_mfma_f32_16x16x32_bf16 v[60:63], v[188:191], v[12:15], v[60:63]
  s_waitcnt vmcnt(9)
  v_mfma_f32_16x16x32_bf16 v[48:51], v[192:195], v[4:7], v[48:51]
  s_add_u32 s6, s6, 3072
  s_load_dword s48, s[32:33], s6 offset:0
  s_load_dword s49, s[32:33], s6 offset:128
  s_load_dword s50, s[32:33], s6 offset:256
  s_load_dword s51, s[32:33], s6 offset:384
  s_load_dword s52, s[32:33], s6 offset:512
  s_load_dword s53, s[32:33], s6 offset:640
  s_add_u32 s76, s83, 196608
  buffer_load_dwordx4 v[12:15], v3, s[36:39], s76 offen offset:0 sc1
  v_mfma_f32_16x16x32_bf16 v[52:55], v[196:199], v[4:7], v[52:55]
  v_mfma_f32_16x16x32_bf16 v[56:59], v[200:203], v[4:7], v[56:59]
  v_mfma_f32_16x16x32_bf16 v[60:63], v[204:207], v[4:7], v[60:63]
  s_waitcnt vmcnt(9)
  v_mfma_f32_16x16x32_bf16 v[48:51], v[208:211], v[8:11], v[48:51]
  buffer_load_dwordx4 v[4:7], v3, s[36:39], s76 offen offset:1024 sc1
  v_mfma_f32_16x16x32_bf16 v[52:55], v[212:215], v[8:11], v[52:55]
  v_mfma_f32_16x16x32_bf16 v[56:59], v[216:219], v[8:11], v[56:59]
  v_mfma_f32_16x16x32_bf16 v[60:63], v[220:223], v[8:11], v[60:63]
  s_waitcnt vmcnt(9)
  v_mfma_f32_16x16x32_bf16 v[48:51], v[224:227], v[16:19], v[48:51]
  s_add_u32 s76, s84, 196608
  buffer_load_dwordx4 v[8:11], v3, s[36:39], s76 offen offset:0 sc1
  v_mfma_f32_16x16x32_bf16 v[52:55], v[228:231], v[16:19], v[52:55]
  v_mfma_f32_16x16x32_bf16 v[56:59], v[232:235], v[16:19], v[56:59]
  v_mfma_f32_16x16x32_bf16 v[60:63], v[236:239], v[16:19], v[60:63]
  s_waitcnt vmcnt(9)
  v_mfma_f32_16x16x32_bf16 v[48:51], v[240:243], v[20:23], v[48:51]
  buffer_load_dwordx4 v[16:19], v3, s[36:39], s76 offen offset:1024 sc1
  v_mfma_f32_16x16x32_bf16 v[52:55], v[244:247], v[20:23], v[52:55]
  v_mfma_f32_16x16x32_bf16 v[56:59], v[248:251], v[20:23], v[56:59]
  v_mfma_f32_16x16x32_bf16 v[60:63], v[252:255], v[20:23], v[60:63]
  s_waitcnt vmcnt(9)
  s_nop 2
  ds_write_b128 v0, v[48:51] offset:256
  v_mfma_f32_16x16x32_bf16 v[48:51], v[64:67], v[24:27], 0
  s_add_u32 s76, s85, 196608
  buffer_load_dwordx4 v[20:23], v3, s[36:39], s76 offen offset:0 sc1
  ds_write_b128 v0, v[52:55] offset:1408
  v_mfma_f32_16x16x32_bf16 v[52:55], v[68:71], v[24:27], 0
  ds_write_b128 v0, v[56:59] offset:2560
  v_mfma_f32_16x16x32_bf16 v[56:59], v[72:75], v[24:27], 0
  ds_write_b128 v0, v[60:63] offset:3712
  v_mfma_f32_16x16x32_bf16 v[60:63], v[76:79], v[24:27], 0
  s_waitcnt vmcnt(9)
  v_mfma_f32_16x16x32_bf16 v[48:51], v[80:83], v[28:31], v[48:51]
  buffer_load_dwordx4 v[24:27], v3, s[36:39], s76 offen offset:1024 sc1
  v_mfma_f32_16x16x32_bf16 v[52:55], v[84:87], v[28:31], v[52:55]
  v_mfma_f32_16x16x32_bf16 v[56:59], v[88:91], v[28:31], v[56:59]
  v_mfma_f32_16x16x32_bf16 v[60:63], v[92:95], v[28:31], v[60:63]
  s_waitcnt vmcnt(9)
  v_mfma_f32_16x16x32_bf16 v[48:51], v[96:99], v[32:35], v[48:51]
  s_add_u32 s76, s80, 245760
  buffer_load_dwordx4 v[28:31], v3, s[36:39], s76 offen offset:0 sc1
  v_mfma_f32_16x16x32_bf16 v[52:55], v[100:103], v[32:35], v[52:55]
  v_mfma_f32_16x16x32_bf16 v[56:59], v[104:107], v[32:35], v[56:59]
  v_mfma_f32_16x16x32_bf16 v[60:63], v[108:111], v[32:35], v[60:63]
  s_waitcnt vmcnt(9)
  v_mfma_f32_16x16x32_bf16 v[48:51], v[112:115], v[36:39], v[48:51]
  buffer_load_dwordx4 v[32:35], v3, s[36:39], s76 offen offset:1024 sc1
  v_mfma_f32_16x16x32_bf16 v[52:55], v[116:119], v[36:39], v[52:55]
  v_mfma_f32_16x16x32_bf16 v[56:59], v[120:123], v[36:39], v[56:59]
  v_mfma_f32_16x16x32_bf16 v[60:63], v[124:127], v[36:39], v[60:63]
  s_waitcnt vmcnt(9)
  v_mfma_f32_16x16x32_bf16 v[48:51], v[128:131], v[40:43], v[48:51]
  s_add_u32 s76, s81, 245760
  buffer_load_dwordx4 v[36:39], v3, s[36:39], s76 offen offset:0 sc1
  v_mfma_f32_16x16x32_bf16 v[52:55], v[132:135], v[40:43], v[52:55]
  v_mfma_f32_16x16x32_bf16 v[56:59], v[136:139], v[40:43], v[56:59]
  v_mfma_f32_16x16x32_bf16 v[60:63], v[140:143], v[40:43], v[60:63]
  s_waitcnt vmcnt(9)
  v_mfma_f32_16x16x32_bf16 v[48:51], v[144:147], v[44:47], v[48:51]
  buffer_load_dwordx4 v[40:43], v3, s[36:39], s76 offen offset:1024 sc1
  v_mfma_f32_16x16x32_bf16 v[52:55], v[148:151], v[44:47], v[52:55]
  v_mfma_f32_16x16x32_bf16 v[56:59], v[152:155], v[44:47], v[56:59]
  v_mfma_f32_16x16x32_bf16 v[60:63], v[156:159], v[44:47], v[60:63]
  s_waitcnt vmcnt(9)
  v_mfma_f32_16x16x32_bf16 v[48:51], v[160:163], v[12:15], v[48:51]
  s_add_u32 s76, s82, 245760
  buffer_load_dwordx4 v[44:47], v3, s[36:39], s76 offen offset:0 sc1
  v_mfma_f32_16x16x32_bf16 v[52:55], v[164:167], v[12:15], v[52:55]
  v_mfma_f32_16x16x32_bf16 v[56:59], v[168:171], v[12:15], v[56:59]
  v_mfma_f32_16x16x32_bf16 v[60:63], v[172:175], v[12:15], v[60:63]
  s_waitcnt vmcnt(9)
  v_mfma_f32_16x16x32_bf16 v[48:51], v[176:179], v[4:7], v[48:51]
  buffer_load_dwordx4 v[12:15], v3, s[36:39], s76 offen offset:1024 sc1
  v_mfma_f32_16x16x32_bf16 v[52:55], v[180:183], v[4:7], v[52:55]
  v_mfma_f32_16x16x32_bf16 v[56:59], v[184:187], v[4:7], v[56:59]
  v_mfma_f32_16x16x32_bf16 v[60:63], v[188:191], v[4:7], v[60:63]
  s_waitcnt vmcnt(9)
  v_mfma_f32_16x16x32_bf16 v[48:51], v[192:195], v[8:11], v[48:51]
  s_add_u32 s76, s83, 245760
  buffer_load_dwordx4 v[4:7], v3, s[36:39], s76 offen offset:0 sc1
  v_mfma_f32_16x16x32_bf16 v[52:55], v[196:199], v[8:11], v[52:55]
  v_mfma_f32_16x16x32_bf16 v[56:59], v[200:203], v[8:11], v[56:59]
  v_mfma_f32_16x16x32_bf16 v[60:63], v[204:207], v[8:11], v[60:63]
  s_waitcnt vmcnt(9)
  v_mfma_f32_16x16x32_bf16 v[48:51], v[208:211], v[16:19], v[48:51]
  buffer_load_dwordx4 v[8:11], v3, s[36:39], s76 offen offset:1024 sc1
  v_mfma_f32_16x16x32_bf16 v[52:55], v[212:215], v[16:19], v[52:55]
  v_mfma_f32_16x16x32_bf16 v[56:59], v[216:219], v[16:19], v[56:59]
  v_mfma_f32_16x16x32_bf16 v[60:63], v[220:223], v[16:19], v[60:63]
  s_waitcnt vmcnt(9)
  v_mfma_f32_16x16x32_bf16 v[48:51], v[224:227], v[20:23], v[48:51]
  s_add_u32 s76, s84, 245760
  buffer_load_dwordx4 v[16:19], v3, s[36:39], s76 offen offset:0 sc1
  v_mfma_f32_16x16x32_bf16 v[52:55], v[228:231], v[20:23], v[52:55]
  v_mfma_f32_16x16x32_bf16 v[56:59], v[232:235], v[20:23], v[56:59]
  v_mfma_f32_16x16x32_bf16 v[60:63], v[236:239], v[20:23], v[60:63]
  s_waitcnt vmcnt(9)
  v_mfma_f32_16x16x32_bf16 v[48:51], v[240:243], v[24:27], v[48:51]
  buffer_load_dwordx4 v[20:23], v3, s[36:39], s76 offen offset:1024 sc1
  v_mfma_f32_16x16x32_bf16 v[52:55], v[244:247], v[24:27], v[52:55]
  v_mfma_f32_16x16x32_bf16 v[56:59], v[248:251], v[24:27], v[56:59]
  v_mfma_f32_16x16x32_bf16 v[60:63], v[252:255], v[24:27], v[60:63]
  s_waitcnt lgkmcnt(0)
  s_barrier
  s_waitcnt vmcnt(9)
  v_add_u32 v0, 36864, v0
  ds_write_b128 v0, v[48:51] offset:0
  v_mfma_f32_16x16x32_bf16 v[48:51], v[64:67], v[28:31], 0
  s_add_u32 s76, s85, 245760
  buffer_load_dwordx4 v[24:27], v3, s[36:39], s76 offen offset:0 sc1
  ds_write_b128 v0, v[52:55] offset:1152
  v_mfma_f32_16x16x32_bf16 v[52:55], v[68:71], v[28:31], 0
  ds_write_b128 v0, v[56:59] offset:2304
  v_mfma_f32_16x16x32_bf16 v[56:59], v[72:75], v[28:31], 0
  ds_write_b128 v0, v[60:63] offset:3456
  v_mfma_f32_16x16x32_bf16 v[60:63], v[76:79], v[28:31], 0
  s_waitcnt vmcnt(9)
  v_mfma_f32_16x16x32_bf16 v[48:51], v[80:83], v[32:35], v[48:51]
  buffer_load_dwordx4 v[28:31], v3, s[36:39], s76 offen offset:1024 sc1
  v_mfma_f32_16x16x32_bf16 v[52:55], v[84:87], v[32:35], v[52:55]
  v_mfma_f32_16x16x32_bf16 v[56:59], v[88:91], v[32:35], v[56:59]
  v_mfma_f32_16x16x32_bf16 v[60:63], v[92:95], v[32:35], v[60:63]
  s_waitcnt vmcnt(9)
  v_mfma_f32_16x16x32_bf16 v[48:51], v[96:99], v[36:39], v[48:51]
  s_mov_b32 s71, 0
L_spoll_7:
  s_waitcnt lgkmcnt(0)
  s_xor_b32 s48, s48, s63
  s_xor_b32 s49, s49, s63
  s_xor_b32 s50, s50, s63
  s_xor_b32 s51, s51, s63
  s_xor_b32 s52, s52, s63
  s_xor_b32 s53, s53, s63
  s_or_b32 s48, s48, s49
  s_or_b32 s48, s48, s50
  s_or_b32 s48, s48, s51
  s_or_b32 s48, s48, s52
  s_or_b32 s48, s48, s53
  s_cmp_eq_u32 s48, 0
  s_cbranch_scc1 L_sready_8
  s_add_u32 s71, s71, 1
  s_cmp_ge_u32 s71, 200000
  s_cbranch_scc1 L_sready_8
  s_load_dword s48, s[32:33], s6 offset:0 glc
  s_load_dword s49, s[32:33], s6 offset:128 glc
  s_load_dword s50, s[32:33], s6 offset:256 glc
  s_load_dword s51, s[32:33], s6 offset:384 glc
  s_load_dword s52, s[32:33], s6 offset:512 glc
  s_load_dword s53, s[32:33], s6 offset:640 glc
  s_branch L_spoll_7
L_sready_8:
  s_add_u32 s76, s80, 393216
  buffer_load_dwordx4 v[32:35], v3, s[36:39], s76 offen offset:0 sc1
  v_mfma_f32_16x16x32_bf16 v[52:55], v[100:103], v[36:39], v[52:55]
  v_mfma_f32_16x16x32_bf16 v[56:59], v[104:107], v[36:39], v[56:59]
  v_mfma_f32_16x16x32_bf16 v[60:63], v[108:111], v[36:39], v[60:63]
  s_waitcnt vmcnt(9)
  v_mfma_f32_16x16x32_bf16 v[48:51], v[112:115], v[40:43], v[48:51]
  buffer_load_dwordx4 v[36:39], v3, s[36:39], s76 offen offset:1024 sc1
  v_mfma_f32_16x16x32_bf16 v[52:55], v[116:119], v[40:43], v[52:55]
  v_mfma_f32_16x16x32_bf16 v[56:59], v[120:123], v[40:43], v[56:59]
  v_mfma_f32_16x16x32_bf16 v[60:63], v[124:127], v[40:43], v[60:63]
  s_waitcnt vmcnt(9)
  v_mfma_f32_16x16x32_bf16 v[48:51], v[128:131], v[44:47], v[48:51]
  s_add_u32 s76, s81, 393216
  buffer_load_dwordx4 v[40:43], v3, s[36:39], s76 offen offset:0 sc1
  v_mfma_f32_16x16x32_bf16 v[52:55], v[132:135], v[44:47], v[52:55]
  v_mfma_f32_16x16x32_bf16 v[56:59], v[136:139], v[44:47], v[56:59]
  v_mfma_f32_16x16x32_bf16 v[60:63], v[140:143], v[44:47], v[60:63]
  s_waitcnt vmcnt(9)
  v_mfma_f32_16x16x32_bf16 v[48:51], v[144:147], v[12:15], v[48:51]
  buffer_load_dwordx4 v[44:47], v3, s[36:39], s76 offen offset:1024 sc1
  v_mfma_f32_16x16x32_bf16 v[52:55], v[148:151], v[12:15], v[52:55]
  v_mfma_f32_16x16x32_bf16 v[56:59], v[152:155], v[12:15], v[56:59]
  v_mfma_f32_16x16x32_bf16 v[60:63], v[156:159], v[12:15], v[60:63]
  s_waitcnt vmcnt(9)
  v_mfma_f32_16x16x32_bf16 v[48:51], v[160:163], v[4:7], v[48:51]
  s_add_u32 s76, s82, 393216
  buffer_load_dwordx4 v[12:15], v3, s[36:39], s76 offen offset:0 sc1
  v_mfma_f32_16x16x32_bf16 v[52:55], v[164:167], v[4:7], v[52:55]
  v_mfma_f32_16x16x32_bf16 v[56:59], v[168:171], v[4:7], v[56:59]
  v_mfma_f32_16x16x32_bf16 v[60:63], v[172:175], v[4:7], v[60:63]
  s_waitcnt vmcnt(9)
  v_mfma_f32_16x16x32_bf16 v[48:51], v[176:179], v[8:11], v[48:51]
  buffer_load_dwordx4 v[4:7], v3, s[36:39], s76 offen offset:1024 sc1
  v_mfma_f32_16x16x32_bf16 v[52:55], v[180:183], v[8:11], v[52:55]
  v_mfma_f32_16x16x32_bf16 v[56:59], v[184:187], v[8:11], v[56:59]
  v_mfma_f32_16x16x32_bf16 v[60:63], v[188:191], v[8:11], v[60:63]
  s_waitcnt vmcnt(9)
  v_mfma_f32_16x16x32_bf16 v[48:51], v[192:195], v[16:19], v[48:51]
  s_add_u32 s76, s83, 393216
  buffer_load_dwordx4 v[8:11], v3, s[36:39], s76 offen offset:0 sc1
  v_mfma_f32_16x16x32_bf16 v[52:55], v[196:199], v[16:19], v[52:55]
  v_mfma_f32_16x16x32_bf16 v[56:59], v[200:203], v[16:19], v[56:59]
  v_mfma_f32_16x16x32_bf16 v[60:63], v[204:207], v[16:19], v[60:63]
  s_waitcnt vmcnt(9)
  v_mfma_f32_16x16x32_bf16 v[48:51], v[208:211], v[20:23], v[48:51]
  buffer_load_dwordx4 v[16:19], v3, s[36:39], s76 offen offset:1024 sc1
  v_mfma_f32_16x16x32_bf16 v[52:55], v[212:215], v[20:23], v[52:55]
  v_mfma_f32_16x16x32_bf16 v[56:59], v[216:219], v[20:23], v[56:59]
  v_mfma_f32_16x16x32_bf16 v[60:63], v[220:223], v[20:23], v[60:63]
  s_waitcnt vmcnt(9)
  v_mfma_f32_16x16x32_bf16 v[48:51], v[224:227], v[24:27], v[48:51]
  s_add_u32 s76, s84, 393216
  buffer_load_dwordx4 v[20:23], v3, s[36:39], s76 offen offset:0 sc1
  v_mfma_f32_16x16x32_bf16 v[52:55], v[228:231], v[24:27], v[52:55]
  v_mfma_f32_16x16x32_bf16 v[56:59], v[232:235], v[24:27], v[56:59]
  v_mfma_f32_16x16x32_bf16 v[60:63], v[236:239], v[24:27], v[60:63]
  s_waitcnt vmcnt(9)
  v_mfma_f32_16x16x32_bf16 v[48:51], v[240:243], v[28:31], v[48:51]
  buffer_load_dwordx4 v[24:27], v3, s[36:39], s76 offen offset:1024 sc1
  v_mfma_f32_16x16x32_bf16 v[52:55], v[244:247], v[28:31], v[52:55]
  v_mfma_f32_16x16x32_bf16 v[56:59], v[248:251], v[28:31], v[56:59]
  v_mfma_f32_16x16x32_bf16 v[60:63], v[252:255], v[28:31], v[60:63]
  s_waitcnt vmcnt(9)
  s_nop 2
  ds_write_b128 v0, v[48:51] offset:256
  v_mfma_f32_16x16x32_bf16 v[48:51], v[64:67], v[32:35], 0
  s_add_u32 s76, s85, 393216
  buffer_load_dwordx4 v[28:31], v3, s[36:39], s76 offen offset:0 sc1
  ds_write_b128 v0, v[52:55] offset:1408
  v_mfma_f32_16x16x32_bf16 v[52:55], v[68:71], v[32:35], 0
  ds_write_b128 v0, v[56:59] offset:2560
  v_mfma_f32_16x16x32_bf16 v[56:59], v[72:75], v[32:35], 0
  ds_write_b128 v0, v[60:63] offset:3712
  v_mfma_f32_16x16x32_bf16 v[60:63], v[76:79], v[32:35], 0
  s_waitcnt vmcnt(9)
  v_mfma_f32_16x16x32_bf16 v[48:51], v[80:83], v[36:39], v[48:51]
  buffer_load_dwordx4 v[32:35], v3, s[36:39], s76 offen offset:1024 sc1
  v_mfma_f32_16x16x32_bf16 v[52:55], v[84:87], v[36:39], v[52:55]
  v_mfma_f32_16x16x32_bf16 v[56:59], v[88:91], v[36:39], v[56:59]
  v_mfma_f32_16x16x32_bf16 v[60:63], v[92:95], v[36:39], v[60:63]
  s_waitcnt vmcnt(9)
  v_mfma_f32_16x16x32_bf16 v[48:51], v[96:99], v[40:43], v[48:51]
  s_add_u32 s76, s80, 442368
  buffer_load_dwordx4 v[36:39], v3, s[36:39], s76 offen offset:0 sc1
  v_mfma_f32_16x16x32_bf16 v[52:55], v[100:103], v[40:43], v[52:55]
  v_mfma_f32_16x16x32_bf16 v[56:59], v[104:107], v[40:43], v[56:59]
  v_mfma_f32_16x16x32_bf16 v[60:63], v[108:111], v[40:43], v[60:63]
  s_waitcnt lgkmcnt(0)
  s_barrier
  s_waitcnt vmcnt(9)
  v_mfma_f32_16x16x32_bf16 v[48:51], v[112:115], v[44:47], v[48:51]
  buffer_load_dwordx4 v[40:43], v3, s[36:39], s76 offen offset:1024 sc1
  v_mfma_f32_16x16x32_bf16 v[52:55], v[116:119], v[44:47], v[52:55]
  v_mfma_f32_16x16x32_bf16 v[56:59], v[120:123], v[44:47], v[56:59]
  v_mfma_f32_16x16x32_bf16 v[60:63], v[124:127], v[44:47], v[60:63]
  s_waitcnt vmcnt(9)
  v_mfma_f32_16x16x32_bf16 v[48:51], v[128:131], v[12:15], v[48:51]
  s_add_u32 s76, s81, 442368
  buffer_load_dwordx4 v[44:47], v3, s[36:39], s76 offen offset:0 sc1
  v_mfma_f32_16x16x32_bf16 v[52:55], v[132:135], v[12:15], v[52:55]
  v_mfma_f32_16x16x32_bf16 v[56:59], v[136:139], v[12:15], v[56:59]
  v_mfma_f32_16x16x32_bf16 v[60:63], v[140:143], v[12:15], v[60:63]
  s_waitcnt vmcnt(9)
  v_mfma_f32_16x16x32_bf16 v[48:51], v[144:147], v[4:7], v[48:51]
  s_add_u32 s6, s6, 3072
  s_load_dword s48, s[32:33], s6 offset:0
  s_load_dword s49, s[32:33], s6 offset:128
  s_load_dword s50, s[32:33], s6 offset:256
  s_load_dword s51, s[32:33], s6 offset:384
  s_load_dword s52, s[32:33], s6 offset:512
  s_load_dword s53, s[32:33], s6 offset:640
  buffer_load_dwordx4 v[12:15], v3, s[36:39], s76 offen offset:1024 sc1
  v_mfma_f32_16x16x32_bf16 v[52:55], v[148:151], v[4:7], v[52:55]
  v_mfma_f32_16x16x32_bf16 v[56:59], v[152:155], v[4:7], v[56:59]
  v_mfma_f32_16x16x32_bf16 v[60:63], v[156:159], v[4:7], v[60:63]
  s_waitcnt vmcnt(9)
  v_mfma_f32_16x16x32_bf16 v[48:51], v[160:163], v[8:11], v[48:51]
  s_add_u32 s76, s82, 442368
  buffer_load_dwordx4 v[4:7], v3, s[36:39], s76 offen offset:0 sc1
  v_mfma_f32_16x16x32_bf16 v[52:55], v[164:167], v[8:11], v[52:55]
  v_mfma_f32_16x16x32_bf16 v[56:59], v[168:171], v[8:11], v[56:59]
  v_mfma_f32_16x16x32_bf16 v[60:63], v[172:175], v[8:11], v[60:63]
  s_waitcnt vmcnt(9)
  v_mfma_f32_16x16x32_bf16 v[48:51], v[176:179], v[16:19], v[48:51]
  buffer_load_dwordx4 v[8:11], v3, s[36:39], s76 offen offset:1024 sc1
  v_mfma_f32_16x16x32_bf16 v[52:55], v[180:183], v[16:19], v[52:55]
  v_mfma_f32_16x16x32_bf16 v[56:59], v[184:187], v[16:19], v[56:59]
  v_mfma_f32_16x16x32_bf16 v[60:63], v[188:191], v[16:19], v[60:63]
  s_waitcnt vmcnt(9)
  v_mfma_f32_16x16x32_bf16 v[48:51], v[192:195], v[20:23], v[48:51]
  s_add_u32 s76, s83, 442368
  buffer_load_dwordx4 v[16:19], v3, s[36:39], s76 offen offset:0 sc1
  v_mfma_f32_16x16x32_bf16 v[52:55], v[196:199], v[20:23], v[52:55]
  v_mfma_f32_16x16x32_bf16 v[56:59], v[200:203], v[20:23], v[56:59]
  v_mfma_f32_16x16x32_bf16 v[60:63], v[204:207], v[20:23], v[60:63]
  s_waitcnt vmcnt(9)
  v_mfma_f32_16x16x32_bf16 v[48:51], v[208:211], v[24:27], v[48:51]
  buffer_load_dwordx4 v[20:23], v3, s[36:39], s76 offen offset:1024 sc1
  v_mfma_f32_16x16x32_bf16 v[52:55], v[212:215], v[24:27], v[52:55]
  v_mfma_f32_16x16x32_bf16 v[56:59], v[216:219], v[24:27], v[56:59]
  v_mfma_f32_16x16x32_bf16 v[60:63], v[220:223], v[24:27], v[60:63]
  s_waitcnt vmcnt(9)
  v_mfma_f32_16x16x32_bf16 v[48:51], v[224:227], v[28:31], v[48:51]
  s_add_u32 s76, s84, 442368
  buffer_load_dwordx4 v[24:27], v3, s[36:39], s76 offen offset:0 sc1
  v_mfma_f32_16x16x32_bf16 v[52:55], v[228:231], v[28:31], v[52:55]
  v_mfma_f32_16x16x32_bf16 v[56:59], v[232:235], v[28:31], v[56:59]
  v_mfma_f32_16x16x32_bf16 v[60:63], v[236:239], v[28:31], v[60:63]
  s_waitcnt vmcnt(9)
  v_mfma_f32_16x16x32_bf16 v[48:51], v[240:243], v[32:35], v[48:51]
  buffer_load_dwordx4 v[28:31], v3, s[36:39], s76 offen offset:1024 sc1
  v_mfma_f32_16x16x32_bf16 v[52:55], v[244:247], v[32:35], v[52:55]
  v_mfma_f32_16x16x32_bf16 v[56:59], v[248:251], v[32:35], v[56:59]
  v_mfma_f32_16x16x32_bf16 v[60:63], v[252:255], v[32:35], v[60:63]
  s_waitcnt vmcnt(9)
  v_subrev_u32 v0, 36864, v0
  s_nop 1
  ds_write_b128 v0, v[48:51] offset:0
  v_mfma_f32_16x16x32_bf16 v[48:51], v[64:67], v[36:39], 0
  s_add_u32 s76, s85, 442368
  buffer_load_dwordx4 v[32:35], v3, s[36:39], s76 offen offset:0 sc1
  ds_write_b128 v0, v[52:55] offset:1152
  v_mfma_f32_16x16x32_bf16 v[52:55], v[68:71], v[36:39], 0
  ds_write_b128 v0, v[56:59] offset:2304
  v_mfma_f32_16x16x32_bf16 v[56:59], v[72:75], v[36:39], 0
  ds_write_b128 v0, v[60:63] offset:3456
  v_mfma_f32_16x16x32_bf16 v[60:63], v[76:79], v[36:39], 0
  s_waitcnt vmcnt(9)
  v_mfma_f32_16x16x32_bf16 v[48:51], v[80:83], v[40:43], v[48:51]
  buffer_load_dwordx4 v[36:39], v3, s[36:39], s76 offen offset:1024 sc1
  v_mfma_f32_16x16x32_bf16 v[52:55], v[84:87], v[40:43], v[52:55]
  v_mfma_f32_16x16x32_bf16 v[56:59], v[88:91], v[40:43], v[56:59]
  v_mfma_f32_16x16x32_bf16 v[60:63], v[92:95], v[40:43], v[60:63]
  s_waitcnt vmcnt(9)
  v_mfma_f32_16x16x32_bf16 v[48:51], v[96:99], v[44:47], v[48:51]
  s_mov_b32 s71, 0
L_spoll_10:
  s_waitcnt lgkmcnt(0)
  s_xor_b32 s48, s48, s63
  s_xor_b32 s49, s49, s63
  s_xor_b32 s50, s50, s63
  s_xor_b32 s51, s51, s63
  s_xor_b32 s52, s52, s63
  s_xor_b32 s53, s53, s63
  s_or_b32 s48, s48, s49
  s_or_b32 s48, s48, s50
  s_or_b32 s48, s48, s51
  s_or_b32 s48, s48, s52
  s_or_b32 s48, s48, s53
  s_cmp_eq_u32 s48, 0
  s_cbranch_scc1 L_sready_11
  s_add_u32 s71, s71, 1
  s_cmp_ge_u32 s71, 200000
  s_cbranch_scc1 L_sready_11
  s_load_dword s48, s[32:33], s6 offset:0 glc
  s_load_dword s49, s[32:33], s6 offset:128 glc
  s_load_dword s50, s[32:33], s6 offset:256 glc
  s_load_dword s51, s[32:33], s6 offset:384 glc
  s_load_dword s52, s[32:33], s6 offset:512 glc
  s_load_dword s53, s[32:33], s6 offset:640 glc
  s_branch L_spoll_10
L_sready_11:
  s_add_u32 s76, s80, 589824
  buffer_load_dwordx4 v[40:43], v3, s[36:39], s76 offen offset:0 sc1
  v_mfma_f32_16x16x32_bf16 v[52:55], v[100:103], v[44:47], v[52:55]
  v_mfma_f32_16x16x32_bf16 v[56:59], v[104:107], v[44:47], v[56:59]
  v_mfma_f32_16x16x32_bf16 v[60:63], v[108:111], v[44:47], v[60:63]
  s_waitcnt vmcnt(9)
  v_mfma_f32_16x16x32_bf16 v[48:51], v[112:115], v[12:15], v[48:51]
  buffer_load_dwordx4 v[44:47], v3, s[36:39], s76 offen offset:1024 sc1
  v_mfma_f32_16x16x32_bf16 v[52:55], v[116:119], v[12:15], v[52:55]
  v_mfma_f32_16x16x32_bf16 v[56:59], v[120:123], v[12:15], v[56:59]
  v_mfma_f32_16x16x32_bf16 v[60:63], v[124:127], v[12:15], v[60:63]
  s_waitcnt vmcnt(9)
  v_mfma_f32_16x16x32_bf16 v[48:51], v[128:131], v[4:7], v[48:51]
  s_add_u32 s76, s81, 589824
  buffer_load_dwordx4 v[12:15], v3, s[36:39], s76 offen offset:0 sc1
  v_mfma_f32_16x16x32_bf16 v[52:55], v[132:135], v[4:7], v[52:55]
  v_mfma_f32_16x16x32_bf16 v[56:59], v[136:139], v[4:7], v[56:59]
  v_mfma_f32_16x16x32_bf16 v[60:63], v[140:143], v[4:7], v[60:63]
  s_waitcnt vmcnt(9)
  v_mfma_f32_16x16x32_bf16 v[48:51], v[144:147], v[8:11], v[48:51]
  buffer_load_dwordx4 v[4:7], v3, s[36:39], s76 offen offset:1024 sc1
  v_mfma_f32_16x16x32_bf16 v[52:55], v[148:151], v[8:11], v[52:55]
  v_mfma_f32_16x16x32_bf16 v[56:59], v[152:155], v[8:11], v[56:59]
  v_mfma_f32_16x16x32_bf16 v[60:63], v[156:159], v[8:11], v[60:63]
  s_waitcnt vmcnt(9)
  v_mfma_f32_16x16x32_bf16 v[48:51], v[160:163], v[16:19], v[48:51]
  s_add_u32 s76, s82, 589824
  buffer_load_dwordx4 v[8:11], v3, s[36:39], s76 offen offset:0 sc1
  v_mfma_f32_16x16x32_bf16 v[52:55], v[164:167], v[16:19], v[52:55]
  v_mfma_f32_16x16x32_bf16 v[56:59], v[168:171], v[16:19], v[56:59]
  v_mfma_f32_16x16x32_bf16 v[60:63], v[172:175], v[16:19], v[60:63]
  s_waitcnt vmcnt(9)
  v_mfma_f32_16x16x32_bf16 v[48:51], v[176:179], v[20:23], v[48:51]
  buffer_load_dwordx4 v[16:19], v3, s[36:39], s76 offen offset:1024 sc1
  v_mfma_f32_16x16x32_bf16 v[52:55], v[180:183], v[20:23], v[52:55]
  v_mfma_f32_16x16x32_bf16 v[56:59], v[184:187], v[20:23], v[56:59]
  v_mfma_f32_16x16x32_bf16 v[60:63], v[188:191], v[20:23], v[60:63]
  s_waitcnt vmcnt(9)
  v_mfma_f32_16x16x32_bf16 v[48:51], v[192:195], v[24:27], v[48:51]
  s_load_dword s48, s[32:33], s56 offset:0
  s_load_dword s49, s[32:33], s56 offset:128
  s_load_dword s50, s[32:33], s56 offset:256
  s_load_dword s51, s[32:33], s56 offset:384
  s_load_dword s52, s[32:33], s56 offset:512
  s_load_dword s53, s[32:33], s56 offset:640
  s_load_dword s54, s[32:33], s56 offset:768
  s_load_dword s55, s[32:33], s56 offset:896
  s_add_u32 s76, s83, 589824
  buffer_load_dwordx4 v[20:23], v3, s[36:39], s76 offen offset:0 sc1
  v_mfma_f32_16x16x32_bf16 v[52:55], v[196:199], v[24:27], v[52:55]
  v_mfma_f32_16x16x32_bf16 v[56:59], v[200:203], v[24:27], v[56:59]
  v_mfma_f32_16x16x32_bf16 v[60:63], v[204:207], v[24:27], v[60:63]
  s_waitcnt vmcnt(9)
  v_mfma_f32_16x16x32_bf16 v[48:51], v[208:211], v[28:31], v[48:51]
  buffer_load_dwordx4 v[24:27], v3, s[36:39], s76 offen offset:1024 sc1
  v_mfma_f32_16x16x32_bf16 v[52:55], v[212:215], v[28:31], v[52:55]
  v_mfma_f32_16x16x32_bf16 v[56:59], v[216:219], v[28:31], v[56:59]
  v_mfma_f32_16x16x32_bf16 v[60:63], v[220:223], v[28:31], v[60:63]
  s_waitcnt vmcnt(9)
  v_mfma_f32_16x16x32_bf16 v[48:51], v[224:227], v[32:35], v[48:51]
  s_add_u32 s76, s84, 589824
  buffer_load_dwordx4 v[28:31], v3, s[36:39], s76 offen offset:0 sc1
  v_mfma_f32_16x16x32_bf16 v[52:55], v[228:231], v[32:35], v[52:55]
  v_mfma_f32_16x16x32_bf16 v[56:59], v[232:235], v[32:35], v[56:59]
  v_mfma_f32_16x16x32_bf16 v[60:63], v[236:239], v[32:35], v[60:63]
  s_waitcnt vmcnt(9)
  v_mfma_f32_16x16x32_bf16 v[48:51], v[240:243], v[36:39], v[48:51]
  buffer_load_dwordx4 v[32:35], v3, s[36:39], s76 offen offset:1024 sc1
  v_mfma_f32_16x16x32_bf16 v[52:55], v[244:247], v[36:39], v[52:55]
  v_mfma_f32_16x16x32_bf16 v[56:59], v[248:251], v[36:39], v[56:59]
  v_mfma_f32_16x16x32_bf16 v[60:63], v[252:255], v[36:39], v[60:63]
  s_waitcnt vmcnt(9)
  s_nop 2
  ds_write_b128 v0, v[48:51] offset:256
  v_mfma_f32_16x16x32_bf16 v[48:51], v[64:67], v[40:43], 0
  s_mov_b32 s71, 0
L_spoll_13:
  s_waitcnt lgkmcnt(0)
  s_xor_b32 s48, s48, s63
  s_xor_b32 s49, s49, s63
  s_xor_b32 s50, s50, s63
  s_xor_b32 s51, s51, s63
  s_xor_b32 s52, s52, s63
  s_xor_b32 s53, s53, s63
  s_xor_b32 s54, s54, s63
  s_xor_b32 s55, s55, s63
  s_or_b32 s48, s48, s49
  s_or_b32 s48, s48, s50
  s_or_b32 s48, s48, s51
  s_or_b32 s48, s48, s52
  s_or_b32 s48, s48, s53
  s_or_b32 s48, s48, s54
  s_or_b32 s48, s48, s55
  s_cmp_eq_u32 s48, 0
  s_cbranch_scc1 L_sready_14
  s_add_u32 s71, s71, 1
  s_cmp_ge_u32 s71, 200000
  s_cbranch_scc1 L_sready_14
  s_load_dword s48, s[32:33], s56 offset:0 glc
  s_load_dword s49, s[32:33], s56 offset:128 glc
  s_load_dword s50, s[32:33], s56 offset:256 glc
  s_load_dword s51, s[32:33], s56 offset:384 glc
  s_load_dword s52, s[32:33], s56 offset:512 glc
  s_load_dword s53, s[32:33], s56 offset:640 glc
  s_load_dword s54, s[32:33], s56 offset:768 glc
  s_load_dword s55, s[32:33], s56 offset:896 glc
  s_branch L_spoll_13
L_sready_14:
  s_add_u32 m0, s57, 122880
  s_mov_b32 s78, 0
  buffer_load_dwordx4 v1, s[36:39], s78 offen sc1 lds
  s_add_u32 m0, s57, 123904
  s_mov_b32 s78, 16896
  buffer_load_dwordx4 v1, s[36:39], s78 offen sc1 lds
  s_add_u32 m0, s57, 124928
  s_mov_b32 s78, 33792
  buffer_load_dwordx4 v2, s[36:39], s78 offen sc1 lds
  s_add_u32 m0, s57, 125952
  s_mov_b32 s78, 50688
  buffer_load_dwordx4 v2, s[36:39], s78 offen sc1 lds
  s_add_u32 s76, s85, 589824
  buffer_load_dwordx4 v[36:39], v3, s[36:39], s76 offen offset:0 sc1
  ds_write_b128 v0, v[52:55] offset:1408
  v_mfma_f32_16x16x32_bf16 v[52:55], v[68:71], v[40:43], 0
  ds_write_b128 v0, v[56:59] offset:2560
  v_mfma_f32_16x16x32_bf16 v[56:59], v[72:75], v[40:43], 0
  ds_write_b128 v0, v[60:63] offset:3712
  v_mfma_f32_16x16x32_bf16 v[60:63], v[76:79], v[40:43], 0
  s_waitcnt vmcnt(13)
  v_mfma_f32_16x16x32_bf16 v[48:51], v[80:83], v[44:47], v[48:51]
  buffer_load_dwordx4 v[40:43], v3, s[36:39], s76 offen offset:1024 sc1
  v_mfma_f32_16x16x32_bf16 v[52:55], v[84:87], v[44:47], v[52:55]
  v_mfma_f32_16x16x32_bf16 v[56:59], v[88:91], v[44:47], v[56:59]
  v_mfma_f32_16x16x32_bf16 v[60:63], v[92:95], v[44:47], v[60:63]
  s_waitcnt vmcnt(13)
  v_mfma_f32_16x16x32_bf16 v[48:51], v[96:99], v[12:15], v[48:51]
  s_add_u32 s76, s80, 638976
  buffer_load_dwordx4 v[44:47], v3, s[36:39], s76 offen offset:0 sc1
  v_mfma_f32_16x16x32_bf16 v[52:55], v[100:103], v[12:15], v[52:55]
  v_mfma_f32_16x16x32_bf16 v[56:59], v[104:107], v[12:15], v[56:59]
  v_mfma_f32_16x16x32_bf16 v[60:63], v[108:111], v[12:15], v[60:63]
  s_waitcnt lgkmcnt(0)
  s_barrier
  s_waitcnt vmcnt(13)
  v_mfma_f32_16x16x32_bf16 v[48:51], v[112:115], v[4:7], v[48:51]
  buffer_load_dwordx4 v[12:15], v3, s[36:39], s76 offen offset:1024 sc1
  v_mfma_f32_16x16x32_bf16 v[52:55], v[116:119], v[4:7], v[52:55]
  v_mfma_f32_16x16x32_bf16 v[56:59], v[120:123], v[4:7], v[56:59]
  v_mfma_f32_16x16x32_bf16 v[60:63], v[124:127], v[4:7], v[60:63]
  s_waitcnt vmcnt(13)
  v_mfma_f32_16x16x32_bf16 v[48:51], v[128:131], v[8:11], v[48:51]
  s_add_u32 s76, s81, 638976
  buffer_load_dwordx4 v[4:7], v3, s[36:39], s76 offen offset:0 sc1
  v_mfma_f32_16x16x32_bf16 v[52:55], v[132:135], v[8:11], v[52:55]
  v_mfma_f32_16x16x32_bf16 v[56:59], v[136:139], v[8:11], v[56:59]
  v_mfma_f32_16x16x32_bf16 v[60:63], v[140:143], v[8:11], v[60:63]
  s_waitcnt vmcnt(13)
  v_mfma_f32_16x16x32_bf16 v[48:51], v[144:147], v[16:19], v[48:51]
  buffer_load_dwordx4 v[8:11], v3, s[36:39], s76 offen offset:1024 sc1
  v_mfma_f32_16x16x32_bf16 v[52:55], v[148:151], v[16:19], v[52:55]
  v_mfma_f32_16x16x32_bf16 v[56:59], v[152:155], v[16:19], v[56:59]
  v_mfma_f32_16x16x32_bf16 v[60:63], v[156:159], v[16:19], v[60:63]
  s_waitcnt vmcnt(13)
  v_mfma_f32_16x16x32_bf16 v[48:51], v[160:163], v[20:23], v[48:51]
  s_add_u32 s76, s82, 638976
  buffer_load_dwordx4 v[16:19], v3, s[36:39], s76 offen offset:0 sc1
  v_mfma_f32_16x16x32_bf16 v[52:55], v[164:167], v[20:23], v[52:55]
  v_mfma_f32_16x16x32_bf16 v[56:59], v[168:171], v[20:23], v[56:59]
  v_mfma_f32_16x16x32_bf16 v[60:63], v[172:175], v[20:23], v[60:63]
  s_waitcnt vmcnt(13)
  v_mfma_f32_16x16x32_bf16 v[48:51], v[176:179], v[24:27], v[48:51]
  buffer_load_dwordx4 v[20:23], v3, s[36:39], s76 offen offset:1024 sc1
  v_mfma_f32_16x16x32_bf16 v[52:55], v[180:183], v[24:27], v[52:55]
  v_mfma_f32_16x16x32_bf16 v[56:59], v[184:187], v[24:27], v[56:59]
  v_mfma_f32_16x16x32_bf16 v[60:63], v[188:191], v[24:27], v[60:63]
  s_waitcnt vmcnt(13)
  v_mfma_f32_16x16x32_bf16 v[48:51], v[192:195], v[28:31], v[48:51]
  s_add_u32 s76, s83, 638976
  buffer_load_dwordx4 v[24:27], v3, s[36:39], s76 offen offset:0 sc1
  v_mfma_f32_16x16x32_bf16 v[52:55], v[196:199], v[28:31], v[52:55]
  v_mfma_f32_16x16x32_bf16 v[56:59], v[200:203], v[28:31], v[56:59]
  v_mfma_f32_16x16x32_bf16 v[60:63], v[204:207], v[28:31], v[60:63]
  s_waitcnt vmcnt(13)
  v_mfma_f32_16x16x32_bf16 v[48:51], v[208:211], v[32:35], v[48:51]
  buffer_load_dwordx4 v[28:31], v3, s[36:39], s76 offen offset:1024 sc1
  v_mfma_f32_16x16x32_bf16 v[52:55], v[212:215], v[32:35], v[52:55]
  v_mfma_f32_16x16x32_bf16 v[56:59], v[216:219], v[32:35], v[56:59]
  v_mfma_f32_16x16x32_bf16 v[60:63], v[220:223], v[32:35], v[60:63]
  s_waitcnt vmcnt(9)
  v_mfma_f32_16x16x32_bf16 v[48:51], v[224:227], v[36:39], v[48:51]
  s_add_u32 s76, s84, 638976
  buffer_load_dwordx4 v[32:35], v3, s[36:39], s76 offen offset:0 sc1
  v_mfma_f32_16x16x32_bf16 v[52:55], v[228:231], v[36:39], v[52:55]
  v_mfma_f32_16x16x32_bf16 v[56:59], v[232:235], v[36:39], v[56:59]
  v_mfma_f32_16x16x32_bf16 v[60:63], v[236:239], v[36:39], v[60:63]
  s_waitcnt vmcnt(9)
  v_mfma_f32_16x16x32_bf16 v[48:51], v[240:243], v[40:43], v[48:51]
  buffer_load_dwordx4 v[36:39], v3, s[36:39], s76 offen offset:1024 sc1
  v_mfma_f32_16x16x32_bf16 v[52:55], v[244:247], v[40:43], v[52:55]
  v_mfma_f32_16x16x32_bf16 v[56:59], v[248:251], v[40:43], v[56:59]
  v_mfma_f32_16x16x32_bf16 v[60:63], v[252:255], v[40:43], v[60:63]
  s_waitcnt vmcnt(9)
  v_add_u32 v0, 36864, v0
  s_nop 1
  ds_write_b128 v0, v[48:51] offset:0
  v_mfma_f32_16x16x32_bf16 v[48:51], v[64:67], v[44:47], 0
  s_add_u32 s76, s85, 638976
  buffer_load_dwordx4 v[40:43], v3, s[36:39], s76 offen offset:0 sc1
  ds_write_b128 v0, v[52:55] offset:1152
  v_mfma_f32_16x16x32_bf16 v[52:55], v[68:71], v[44:47], 0
  ds_write_b128 v0, v[56:59] offset:2304
  v_mfma_f32_16x16x32_bf16 v[56:59], v[72:75], v[44:47], 0
  ds_write_b128 v0, v[60:63] offset:3456
  v_mfma_f32_16x16x32_bf16 v[60:63], v[76:79], v[44:47], 0
  s_barrier
  s_waitcnt vmcnt(9)
  v_mfma_f32_16x16x32_bf16 v[48:51], v[80:83], v[12:15], v[48:51]
  buffer_load_dwordx4 v[44:47], v3, s[36:39], s76 offen offset:1024 sc1
  v_mfma_f32_16x16x32_bf16 v[52:55], v[84:87], v[12:15], v[52:55]
  v_mfma_f32_16x16x32_bf16 v[56:59], v[88:91], v[12:15], v[56:59]
  v_mfma_f32_16x16x32_bf16 v[60:63], v[92:95], v[12:15], v[60:63]
  s_waitcnt vmcnt(9)
  v_mfma_f32_16x16x32_bf16 v[48:51], v[96:99], v[4:7], v[48:51]
  v_mfma_f32_16x16x32_bf16 v[52:55], v[100:103], v[4:7], v[52:55]
  v_mfma_f32_16x16x32_bf16 v[56:59], v[104:107], v[4:7], v[56:59]
  v_mfma_f32_16x16x32_bf16 v[60:63], v[108:111], v[4:7], v[60:63]
  s_waitcnt vmcnt(8)
  v_mfma_f32_16x16x32_bf16 v[48:51], v[112:115], v[8:11], v[48:51]
  v_mfma_f32_16x16x32_bf16 v[52:55], v[116:119], v[8:11], v[52:55]
  v_mfma_f32_16x16x32_bf16 v[56:59], v[120:123], v[8:11], v[56:59]
  v_mfma_f32_16x16x32_bf16 v[60:63], v[124:127], v[8:11], v[60:63]
  s_waitcnt vmcnt(7)
  v_mfma_f32_16x16x32_bf16 v[48:51], v[128:131], v[16:19], v[48:51]
  v_mfma_f32_16x16x32_bf16 v[52:55], v[132:135], v[16:19], v[52:55]
  v_mfma_f32_16x16x32_bf16 v[56:59], v[136:139], v[16:19], v[56:59]
  v_mfma_f32_16x16x32_bf16 v[60:63], v[140:143], v[16:19], v[60:63]
  s_waitcnt vmcnt(6)
  v_mfma_f32_16x16x32_bf16 v[48:51], v[144:147], v[20:23], v[48:51]
  v_mfma_f32_16x16x32_bf16 v[52:55], v[148:151], v[20:23], v[52:55]
  v_mfma_f32_16x16x32_bf16 v[56:59], v[152:155], v[20:23], v[56:59]
  v_mfma_f32_16x16x32_bf16 v[60:63], v[156:159], v[20:23], v[60:63]
  s_waitcnt vmcnt(5)
  v_mfma_f32_16x16x32_bf16 v[48:51], v[160:163], v[24:27], v[48:51]
  v_mfma_f32_16x16x32_bf16 v[52:55], v[164:167], v[24:27], v[52:55]
  v_mfma_f32_16x16x32_bf16 v[56:59], v[168:171], v[24:27], v[56:59]
  v_mfma_f32_16x16x32_bf16 v[60:63], v[172:175], v[24:27], v[60:63]
  s_waitcnt vmcnt(4)
  v_mfma_f32_16x16x32_bf16 v[48:51], v[176:179], v[28:31], v[48:51]
  v_mfma_f32_16x16x32_bf16 v[52:55], v[180:183], v[28:31], v[52:55]
  v_mfma_f32_16x16x32_bf16 v[56:59], v[184:187], v[28:31], v[56:59]
  v_mfma_f32_16x16x32_bf16 v[60:63], v[188:191], v[28:31], v[60:63]
  s_waitcnt vmcnt(3)
  v_mfma_f32_16x16x32_bf16 v[48:51], v[192:195], v[32:35], v[48:51]
  v_mfma_f32_16x16x32_bf16 v[52:55], v[196:199], v[32:35], v[52:55]
  v_mfma_f32_16x16x32_bf16 v[56:59], v[200:203], v[32:35], v[56:59]
  v_mfma_f32_16x16x32_bf16 v[60:63], v[204:207], v[32:35], v[60:63]
  s_waitcnt vmcnt(2)
  v_mfma_f32_16x16x32_bf16 v[48:51], v[208:211], v[36:39], v[48:51]
  v_mfma_f32_16x16x32_bf16 v[52:55], v[212:215], v[36:39], v[52:55]
  v_mfma_f32_16x16x32_bf16 v[56:59], v[216:219], v[36:39], v[56:59]
  v_mfma_f32_16x16x32_bf16 v[60:63], v[220:223], v[36:39], v[60:63]
  s_waitcnt vmcnt(1)
  v_mfma_f32_16x16x32_bf16 v[48:51], v[224:227], v[40:43], v[48:51]
  v_mfma_f32_16x16x32_bf16 v[52:55], v[228:231], v[40:43], v[52:55]
  v_mfma_f32_16x16x32_bf16 v[56:59], v[232:235], v[40:43], v[56:59]
  v_mfma_f32_16x16x32_bf16 v[60:63], v[236:239], v[40:43], v[60:63]
  s_waitcnt vmcnt(0)
  v_mfma_f32_16x16x32_bf16 v[48:51], v[240:243], v[44:47], v[48:51]
  v_mfma_f32_16x16x32_bf16 v[52:55], v[244:247], v[44:47], v[52:55]
  v_mfma_f32_16x16x32_bf16 v[56:59], v[248:251], v[44:47], v[56:59]
  v_mfma_f32_16x16x32_bf16 v[60:63], v[252:255], v[44:47], v[60:63]
  s_nop 4
  ds_write_b128 v0, v[48:51] offset:256
  ds_write_b128 v0, v[52:55] offset:1408
  ds_write_b128 v0, v[56:59] offset:2560
  ds_write_b128 v0, v[60:63] offset:3712
  s_waitcnt vmcnt(0) lgkmcnt(0)
  s_barrier
  s_branch L_fin
L_g1c:
  v_add_u32 v24, 40960, v24
  s_add_u32 m0, s4, 0
  s_nop 0
  buffer_load_dwordx4 v24, s[40:43], s80 offen  lds
  s_add_u32 m0, s4, 4096
  s_nop 0
  buffer_load_dwordx4 v24, s[40:43], s81 offen  lds
  s_add_u32 m0, s4, 8192
  s_nop 0
  buffer_load_dwordx4 v24, s[40:43], s82 offen  lds
  s_add_u32 m0, s4, 12288
  s_nop 0
  buffer_load_dwordx4 v24, s[40:43], s83 offen  lds
  s_add_u32 m0, s4, 16384
  s_nop 0
  buffer_load_dwordx4 v24, s[40:43], s84 offen  lds
  s_add_u32 m0, s4, 20480
  s_nop 0
  buffer_load_dwordx4 v24, s[40:43], s85 offen  lds
  s_add_u32 m0, s4, 24576
  s_nop 0
  buffer_load_dwordx4 v24, s[40:43], s86 offen  lds
  s_add_u32 m0, s4, 28672
  s_nop 0
  buffer_load_dwordx4 v24, s[40:43], s87 offen  lds
  s_add_u32 m0, s4, 32768
  s_nop 0
  buffer_load_dwordx4 v24, s[40:43], s88 offen  lds
  s_add_u32 m0, s4, 36864
  s_nop 0
  buffer_load_dwordx4 v24, s[40:43], s89 offen  lds
  v_add_u32 v24, 40960, v24
  s_add_u32 m0, s4, 40960
  s_nop 0
  buffer_load_dwordx4 v24, s[40:43], s80 offen  lds
  s_add_u32 m0, s4, 45056
  s_nop 0
  buffer_load_dwordx4 v24, s[40:43], s81 offen  lds
  s_add_u32 m0, s4, 49152
  s_nop 0
  buffer_load_dwordx4 v24, s[40:43], s82 offen  lds
  s_add_u32 m0, s4, 53248
  s_nop 0
  buffer_load_dwordx4 v24, s[40:43], s83 offen  lds
  s_add_u32 m0, s4, 57344
  s_nop 0
  buffer_load_dwordx4 v24, s[40:43], s84 offen  lds
  s_add_u32 m0, s4, 61440
  s_nop 0
  buffer_load_dwordx4 v24, s[40:43], s85 offen  lds
  s_add_u32 m0, s4, 65536
  s_nop 0
  buffer_load_dwordx4 v24, s[40:43], s86 offen  lds
  s_add_u32 m0, s4, 69632
  s_nop 0
  buffer_load_dwordx4 v24, s[40:43], s87 offen  lds
  s_add_u32 m0, s4, 73728
  s_nop 0
  buffer_load_dwordx4 v24, s[40:43], s88 offen  lds
  s_add_u32 m0, s4, 77824
  s_nop 0
  buffer_load_dwordx4 v24, s[40:43], s89 offen  lds
  s_waitcnt vmcnt(10)
  s_barrier
  v_add_u32 v24, 40960, v24
  s_add_u32 m0, s4, 81920
  s_nop 0
  buffer_load_dwordx4 v24, s[40:43], s80 offen  lds
  s_add_u32 m0, s4, 86016
  s_nop 0
  buffer_load_dwordx4 v24, s[40:43], s81 offen  lds
  s_add_u32 m0, s4, 90112
  s_nop 0
  buffer_load_dwordx4 v24, s[40:43], s82 offen  lds
  s_add_u32 m0, s4, 94208
  s_nop 0
  buffer_load_dwordx4 v24, s[40:43], s83 offen  lds
  s_add_u32 m0, s4, 98304
  s_nop 0
  buffer_load_dwordx4 v24, s[40:43], s84 offen  lds
  s_add_u32 m0, s4, 102400
  s_nop 0
  buffer_load_dwordx4 v24, s[40:43], s85 offen  lds
  s_add_u32 m0, s4, 106496
  s_nop 0
  buffer_load_dwordx4 v24, s[40:43], s86 offen  lds
  s_add_u32 m0, s4, 110592
  s_nop 0
  buffer_load_dwordx4 v24, s[40:43], s87 offen  lds
  s_add_u32 m0, s4, 114688
  s_nop 0
  buffer_load_dwordx4 v24, s[40:43], s88 offen  lds
  s_add_u32 m0, s4, 118784
  s_nop 0
  buffer_load_dwordx4 v24, s[40:43], s89 offen  lds
  s_waitcnt vmcnt(10)
  s_barrier
  v_add_u32 v24, 40960, v24
  s_add_u32 m0, s4, 0
  s_nop 0
  buffer_load_dwordx4 v24, s[40:43], s80 offen  lds
  s_add_u32 m0, s4, 4096
  s_nop 0
  buffer_load_dwordx4 v24, s[40:43], s81 offen  lds
  s_add_u32 m0, s4, 8192
  s_nop 0
  buffer_load_dwordx4 v24, s[40:43], s82 offen  lds
  s_add_u32 m0, s4, 12288
  s_nop 0
  buffer_load_dwordx4 v24, s[40:43], s83 offen  lds
  s_add_u32 m0, s4, 16384
  s_nop 0
  buffer_load_dwordx4 v24, s[40:43], s84 offen  lds
  s_add_u32 m0, s4, 20480
  s_nop 0
  buffer_load_dwordx4 v24, s[40:43], s85 offen  lds
  s_add_u32 m0, s4, 24576
  s_nop 0
  buffer_load_dwordx4 v24, s[40:43], s86 offen  lds
  s_add_u32 m0, s4, 28672
  s_nop 0
  buffer_load_dwordx4 v24, s[40:43], s87 offen  lds
  s_add_u32 m0, s4, 32768
  s_nop 0
  buffer_load_dwordx4 v24, s[40:43], s88 offen  lds
  s_add_u32 m0, s4, 36864
  s_nop 0
  buffer_load_dwordx4 v24, s[40:43], s89 offen  lds
  s_waitcnt vmcnt(10)
  s_barrier
  v_add_u32 v24, 40960, v24
  s_add_u32 m0, s4, 40960
  s_nop 0
  buffer_load_dwordx4 v24, s[40:43], s80 offen  lds
  s_add_u32 m0, s4, 45056
  s_nop 0
  buffer_load_dwordx4 v24, s[40:43], s81 offen  lds
  s_add_u32 m0, s4, 49152
  s_nop 0
  buffer_load_dwordx4 v24, s[40:43], s82 offen  lds
  s_add_u32 m0, s4, 53248
  s_nop 0
  buffer_load_dwordx4 v24, s[40:43], s83 offen  lds
  s_add_u32 m0, s4, 57344
  s_nop 0
  buffer_load_dwordx4 v24, s[40:43], s84 offen  lds
  s_add_u32 m0, s4, 61440
  s_nop 0
  buffer_load_dwordx4 v24, s[40:43], s85 offen  lds
  s_add_u32 m0, s4, 65536
  s_nop 0
  buffer_load_dwordx4 v24, s[40:43], s86 offen  lds
  s_add_u32 m0, s4, 69632
  s_nop 0
  buffer_load_dwordx4 v24, s[40:43], s87 offen  lds
  s_add_u32 m0, s4, 73728
  s_nop 0
  buffer_load_dwordx4 v24, s[40:43], s88 offen  lds
  s_add_u32 m0, s4, 77824
  s_nop 0
  buffer_load_dwordx4 v24, s[40:43], s89 offen  lds
  s_waitcnt vmcnt(10)
  s_barrier
  s_waitcnt vmcnt(0)
  s_barrier
  s_mul_i32 s77, s70, 3
  s_branch L_fin
L_c_head:
  s_lshr_b32 s76, s60, 2
  s_lshl1_add_u32 s4, s2, s76
  s_sub_u32 s4, s4, 192
  s_mul_i32 s5, s76, 20480
L_phase_a:
  s_setprio 3
  s_and_b32 s80, s60, 3
  s_lshr_b32 s81, s4, 5
  s_and_b32 s78, s4, 31
  s_mul_i32 s82, s78, 81920
  s_lshl_b32 s79, s81, 7
  s_add_u32 s82, s82, s79
  s_sub_u32 s82, s82, 10240
  s_mul_i32 s6, s81, 270336
  s_sub_u32 s78, 31, s78
  s_lshl_b32 s78, s78, 7
  s_add_u32 s6, s6, s78
  s_add_u32 s6, s6, 262144
  v_lshrrev_b32 v8, 3, v0
  v_and_b32 v3, 7, v0
  v_mul_u32_u24 v2, 1280, v8
  v_add_u32 v2, s82, v2
  s_lshl_b32 s78, s81, 2
  s_add_u32 s78, s78, s80
  s_lshl_b32 s78, s78, 7
  v_lshlrev_b32 v9, 4, v8
  v_add_u32 v9, s78, v9
  s_waitcnt lgkmcnt(0)
  s_load_dword s63, s[32:33], 0
  s_mov_b32 s36, s32
  s_mov_b32 s37, s33
  s_mov_b32 s38, 14680064
  s_mov_b32 s39, 0x20000
  s_mov_b32 s40, s10
  s_mov_b32 s41, s11
  s_mov_b32 s42, 2621440
  s_mov_b32 s43, 0x20000
  s_mov_b32 s44, s12
  s_mov_b32 s45, s13
  s_mov_b32 s46, 2621440
  s_mov_b32 s47, 0x20000
  s_mov_b32 s56, s14
  s_mov_b32 s57, s15
  s_mov_b32 s58, 5120
  s_mov_b32 s59, 0x20000
  s_add_u32 s83, s80, 4
  s_mul_i32 s78, s80, 10240
  s_and_b32 s79, s80, 7
  v_xor_b32 v10, s79, v3
  v_lshl_add_u32 v10, v10, 4, v2
  v_add_u32 v4, s78, v10
  s_cmp_eq_u32 s80, 0
  s_cselect_b32 s79, 40, 0
  v_mov_b32 v10, 0x7fffffff
  v_cmp_gt_u32 vcc, s79, v0
  s_nop 1
  v_cndmask_b32 v4, v4, v10, vcc
  s_lshl_b32 s78, s80, 10
  s_add_u32 s78, s78, s5
  s_add_u32 m0, s78, 0
  s_nop 0
  buffer_load_dwordx4 v4, s[40:43], 0 offen nt lds
  s_mul_i32 s78, s83, 10240
  s_and_b32 s79, s83, 7
  v_xor_b32 v10, s79, v3
  v_lshl_add_u32 v10, v10, 4, v2
  v_add_u32 v4, s78, v10
  s_lshl_b32 s78, s83, 10
  s_add_u32 s78, s78, s5
  s_add_u32 m0, s78, 0
  s_nop 0
  buffer_load_dwordx4 v4, s[40:43], 0 offen nt lds
  s_mul_i32 s78, s80, 10240
  s_and_b32 s79, s80, 7
  s_add_u32 s78, s78, 10240
  v_xor_b32 v10, s79, v3
  v_lshl_add_u32 v10, v10, 4, v2
  v_add_u32 v4, s78, v10
  s_lshl_b32 s78, s80, 10
  s_add_u32 s78, s78, s5
  s_add_u32 m0, s78, 9216
  s_nop 0
  buffer_load_dwordx4 v4, s[44:47], 0 offen nt lds
  s_mul_i32 s78, s83, 10240
  s_and_b32 s79, s83, 7
  s_add_u32 s78, s78, 10240
  v_xor_b32 v10, s79, v3
  v_lshl_add_u32 v10, v10, 4, v2
  v_add_u32 v4, s78, v10
  s_lshl_b32 s78, s83, 10
  s_add_u32 s78, s78, s5
  s_add_u32 m0, s78, 9216
  s_nop 0
  buffer_load_dwordx4 v4, s[44:47], 0 offen nt lds
  buffer_load_dwordx4 v[16:19], v9, s[56:59], 0 offen
  s_cmp_lg_u32 s80, 3
  s_cbranch_scc1 L_a_no8
  s_mov_b32 s83, 8
  s_mul_i32 s78, s83, 10240
  s_and_b32 s79, s83, 7
  v_xor_b32 v10, s79, v3
  v_lshl_add_u32 v10, v10, 4, v2
  v_add_u32 v4, s78, v10
  s_lshl_b32 s78, s83, 10
  s_add_u32 s78, s78, s5
  s_add_u32 m0, s78, 0
  s_nop 0
  buffer_load_dwordx4 v4, s[40:43], 0 offen nt lds
L_a_no8:
  v_lshrrev_b32 v10, 5, v0
  s_lshl_b32 s78, s80, 1
  v_or_b32 v10, s78, v10
  v_bfe_u32 v11, v0, 3, 2
  v_lshlrev_b32 v11, 2, v11
  v_lshl_add_u32 v11, v3, 10, v11
  v_add_u32 v11, s5, v11
  v_xor_b32 v12, v10, v3
  v_lshl_add_u32 v5, v12, 4, v11
  v_add_u32 v12, 1, v3
  v_and_b32 v12, 7, v12
  v_xor_b32 v12, v12, v10
  v_lshl_add_u32 v6, v12, 4, v11
  s_mul_i32 s78, s80, 67584
  v_mul_u32_u24 v7, 8448, v8
  v_sub_u32 v12, 7, v3
  v_lshl_add_u32 v7, v12, 4, v7
  v_add_u32 v7, s78, v7
  s_waitcnt lgkmcnt(0)
  s_add_u32 s63, s63, 1
  s_cmp_lt_u32 s62, 24
  s_cbranch_scc1 L_a_g
  s_sub_u32 s66, s62, 24
  s_lshl3_add_u32 s65, s61, s66
  s_lshl3_add_u32 s72, s65, s60
  s_mul_i32 s73, s60, 17664
  s_lshr_b32 s64, s61, 2
  s_and_b32 s67, s66, 3
  s_lshl2_add_u32 s64, s64, s67
  s_and_b32 s67, s61, 1
  s_mov_b32 s40, s8
  s_mov_b32 s41, s9
  s_mov_b32 s42, 2621440
  s_mov_b32 s43, 0x20000
  s_lshr_b32 s76, s61, 2
  s_and_b32 s77, s66, 3
  s_lshl2_add_u32 s76, s76, s77
  s_lshl3_add_u32 s76, s76, s60
  s_and_b32 s77, s61, 3
  s_lshl2_add_u32 s76, s76, s77
  s_lshr_b32 s77, s66, 2
  s_lshl1_add_u32 s69, s76, s77
  s_mul_i32 s77, s69, 5120
  v_bfe_u32 v13, v0, 4, 2
  v_mul_u32_u24 v13, 1280, v13
  v_and_b32 v14, 15, v0
  v_lshlrev_b32 v14, 4, v14
  v_add_u32 v13, v13, v14
  buffer_load_dwordx4 v[136:139], v13, s[40:43], s77 offen offset:0
  buffer_load_dwordx4 v[140:143], v13, s[40:43], s77 offen offset:256
  buffer_load_dwordx4 v[144:147], v13, s[40:43], s77 offen offset:512
  buffer_load_dwordx4 v[148:151], v13, s[40:43], s77 offen offset:768
  buffer_load_dwordx4 v[152:155], v13, s[40:43], s77 offen offset:1024
  s_waitcnt vmcnt(5)
  s_branch L_a_join
L_a_g:
  s_waitcnt vmcnt(0)
L_a_join:
  s_barrier
  ds_read_b32 v28, v5 offset:640
  ds_read_b32 v29, v5 offset:768
  ds_read_b32 v30, v5 offset:896
  ds_read_b32 v31, v6 offset:1024
  ds_read_b32 v32, v6 offset:1152
  ds_read_b32 v33, v6 offset:1280
  ds_read_b32 v34, v6 offset:1408
  ds_read_b32 v35, v6 offset:1536
  ds_read_b32 v36, v6 offset:1664
  ds_read_b32 v37, v6 offset:1792
  ds_read_b32 v38, v6 offset:1920
  v_lshlrev_b32 v20, 16, v16
  v_lshlrev_b32 v21, 16, v18
  v_and_b32 v22, 0xffff0000, v16
  v_and_b32 v23, 0xffff0000, v18
  v_lshlrev_b32 v24, 16, v17
  v_lshlrev_b32 v25, 16, v19
  v_and_b32 v26, 0xffff0000, v17
  v_and_b32 v27, 0xffff0000, v19
  s_waitcnt lgkmcnt(5)
  ds_read_b32 v40, v5 offset:9216
  ds_read_b32 v41, v5 offset:9344
  ds_read_b32 v42, v5 offset:9472
  ds_read_b32 v43, v5 offset:9600
  ds_read_b32 v44, v5 offset:9728
  ds_read_b32 v45, v5 offset:9856
  ds_read_b32 v46, v5 offset:9984
  ds_read_b32 v47, v5 offset:10112
  v_lshlrev_b32 v48, 16, v28
  v_and_b32 v49, 0xffff0000, v28
  v_lshlrev_b32 v50, 16, v29
  v_and_b32 v51, 0xffff0000, v29
  v_lshlrev_b32 v52, 16, v30
  v_and_b32 v53, 0xffff0000, v30
  v_lshlrev_b32 v54, 16, v31
  v_and_b32 v55, 0xffff0000, v31
  v_lshlrev_b32 v56, 16, v32
  v_and_b32 v57, 0xffff0000, v32
  v_lshlrev_b32 v58, 16, v33
  v_and_b32 v59, 0xffff0000, v33
  s_waitcnt lgkmcnt(12)
  v_lshlrev_b32 v60, 16, v34
  v_and_b32 v61, 0xffff0000, v34
  s_waitcnt lgkmcnt(11)
  v_lshlrev_b32 v62, 16, v35
  v_and_b32 v63, 0xffff0000, v35
  s_waitcnt lgkmcnt(10)
  v_lshlrev_b32 v64, 16, v36
  v_and_b32 v65, 0xffff0000, v36
  s_waitcnt lgkmcnt(9)
  v_lshlrev_b32 v66, 16, v37
  v_and_b32 v67, 0xffff0000, v37
  s_waitcnt lgkmcnt(8)
  v_lshlrev_b32 v68, 16, v38
  v_and_b32 v69, 0xffff0000, v38
  v_pk_mul_f32 v[86:87], v[48:49], v[26:27]
  v_pk_mul_f32 v[88:89], v[50:51], v[26:27]
  v_pk_mul_f32 v[90:91], v[52:53], v[26:27]
  v_pk_mul_f32 v[92:93], v[54:55], v[26:27]
  v_pk_mul_f32 v[94:95], v[56:57], v[26:27]
  v_pk_mul_f32 v[96:97], v[58:59], v[26:27]
  v_pk_mul_f32 v[98:99], v[60:61], v[26:27]
  v_pk_mul_f32 v[100:101], v[62:63], v[26:27]
  v_pk_fma_f32 v[86:87], v[50:51], v[24:25], v[86:87]
  v_pk_fma_f32 v[88:89], v[52:53], v[24:25], v[88:89]
  v_pk_fma_f32 v[90:91], v[54:55], v[24:25], v[90:91]
  v_pk_fma_f32 v[92:93], v[56:57], v[24:25], v[92:93]
  v_pk_fma_f32 v[94:95], v[58:59], v[24:25], v[94:95]
  v_pk_fma_f32 v[96:97], v[60:61], v[24:25], v[96:97]
  v_pk_fma_f32 v[98:99], v[62:63], v[24:25], v[98:99]
  v_pk_fma_f32 v[100:101], v[64:65], v[24:25], v[100:101]
  v_pk_fma_f32 v[86:87], v[52:53], v[22:23], v[86:87]
  v_pk_fma_f32 v[88:89], v[54:55], v[22:23], v[88:89]
  v_pk_fma_f32 v[90:91], v[56:57], v[22:23], v[90:91]
  v_pk_fma_f32 v[92:93], v[58:59], v[22:23], v[92:93]
  v_pk_fma_f32 v[94:95], v[60:61], v[22:23], v[94:95]
  v_pk_fma_f32 v[96:97], v[62:63], v[22:23], v[96:97]
  v_pk_fma_f32 v[98:99], v[64:65], v[22:23], v[98:99]
  v_pk_fma_f32 v[100:101], v[66:67], v[22:23], v[100:101]
  v_pk_fma_f32 v[86:87], v[54:55], v[20:21], v[86:87]
  v_pk_fma_f32 v[88:89], v[56:57], v[20:21], v[88:89]
  v_pk_fma_f32 v[90:91], v[58:59], v[20:21], v[90:91]
  v_pk_fma_f32 v[92:93], v[60:61], v[20:21], v[92:93]
  v_pk_fma_f32 v[94:95], v[62:63], v[20:21], v[94:95]
  v_pk_fma_f32 v[96:97], v[64:65], v[20:21], v[96:97]
  v_pk_fma_f32 v[98:99], v[66:67], v[20:21], v[98:99]
  v_pk_fma_f32 v[100:101], v[68:69], v[20:21], v[100:101]
  s_waitcnt lgkmcnt(0)
  v_lshlrev_b32 v70, 16, v40
  v_and_b32 v71, 0xffff0000, v40
  v_lshlrev_b32 v72, 16, v41
  v_and_b32 v73, 0xffff0000, v41
  v_lshlrev_b32 v74, 16, v42
  v_and_b32 v75, 0xffff0000, v42
  v_lshlrev_b32 v76, 16, v43
  v_and_b32 v77, 0xffff0000, v43
  v_lshlrev_b32 v78, 16, v44
  v_and_b32 v79, 0xffff0000, v44
  v_lshlrev_b32 v80, 16, v45
  v_and_b32 v81, 0xffff0000, v45
  v_lshlrev_b32 v82, 16, v46
  v_and_b32 v83, 0xffff0000, v46
  v_lshlrev_b32 v84, 16, v47
  v_and_b32 v85, 0xffff0000, v47
  v_pk_mul_f32 v[86:87], v[86:87], v[70:71]
  v_pk_mul_f32 v[88:89], v[88:89], v[72:73]
  v_pk_mul_f32 v[90:91], v[90:91], v[74:75]
  v_pk_mul_f32 v[92:93], v[92:93], v[76:77]
  v_pk_mul_f32 v[94:95], v[94:95], v[78:79]
  v_pk_mul_f32 v[96:97], v[96:97], v[80:81]
  v_pk_mul_f32 v[98:99], v[98:99], v[82:83]
  v_pk_mul_f32 v[100:101], v[100:101], v[84:85]
  v_cvt_pk_bf16_f32 v104, v100, v98
  v_cvt_pk_bf16_f32 v105, v96, v94
  v_cvt_pk_bf16_f32 v106, v92, v90
  v_cvt_pk_bf16_f32 v107, v88, v86
  buffer_store_dwordx4 v[104:107], v7, s[36:39], s6 offen sc1
  v_cvt_pk_bf16_f32 v108, v101, v99
  v_cvt_pk_bf16_f32 v109, v97, v95
  v_cvt_pk_bf16_f32 v110, v93, v91
  v_cvt_pk_bf16_f32 v111, v89, v87
  s_add_u32 s6, s6, 4224
  buffer_store_dwordx4 v[108:111], v7, s[36:39], s6 offen sc1
  s_lshl_b32 s4, s4, 7
  s_add_u32 s4, s4, 81920
  s_setprio 0
  s_cmp_ge_u32 s62, 24
  s_cbranch_scc1 L_role_c
  s_setprio 1
  v_bfe_u32 v22, v0, 4, 1
  v_bfe_u32 v23, v0, 3, 1
  v_lshl_add_u32 v23, v23, 1, v22
  v_xor_b32 v23, s60, v23
  v_lshlrev_b32 v23, 5, v23
  v_bfe_u32 v1, v0, 4, 1
  v_lshlrev_b32 v1, 13, v1
  v_bfe_u32 v24, v0, 5, 1
  v_lshlrev_b32 v24, 10, v24
  v_add_u32 v1, v1, v24
  v_bfe_u32 v24, v0, 2, 2
  v_lshlrev_b32 v24, 7, v24
  v_add_u32 v1, v1, v24
  v_and_b32 v24, 3, v0
  v_lshlrev_b32 v24, 3, v24
  v_add_u32 v1, v1, v24
  v_add_u32 v1, 81920, v1
  v_add_u32 v1, v1, v23
  v_bfe_u32 v22, v0, 1, 3
  v_bfe_u32 v23, v0, 5, 1
  v_and_b32 v24, 31, v0
  v_lshlrev_b32 v24, 7, v24
  v_add_u32 v25, 0, v23
  v_xor_b32 v25, v25, v22
  v_lshl_add_u32 v2, v25, 4, v24
  v_add_u32 v25, 2, v23
  v_xor_b32 v25, v25, v22
  v_lshl_add_u32 v3, v25, 4, v24
  v_add_u32 v25, 4, v23
  v_xor_b32 v25, v25, v22
  v_lshl_add_u32 v4, v25, 4, v24
  v_add_u32 v25, 6, v23
  v_xor_b32 v25, v25, v22
  v_lshl_add_u32 v5, v25, 4, v24
  v_and_b32 v6, 31, v0
  v_lshlrev_b32 v6, 4, v6
  v_add_u32 v6, 155648, v6
  v_bfe_u32 v7, v0, 4, 1
  v_mul_u32_u24 v7, 49152, v7
  v_and_b32 v24, 15, v0
  v_lshlrev_b32 v24, 4, v24
  v_add_u32 v7, v7, v24
  v_bfe_u32 v24, v0, 5, 1
  v_lshlrev_b32 v24, 8, v24
  v_add_u32 v7, v7, v24
  v_mov_b32 v10, 0
  v_mov_b32 v11, 0
  v_mov_b32 v13, 0
  v_mov_b32 v14, 0
  v_mov_b32 v15, 0
  v_bfe_u32 v22, v0, 2, 2
  v_bfe_u32 v23, v0, 4, 1
  v_cmp_eq_u32 vcc, v22, v23
  v_mov_b32 v22, s34
  s_nop 0
  v_cndmask_b32 v28, 0, v22, vcc
  v_mov_b32 v29, v28
  v_mov_b32 v30, v28
  v_mov_b32 v31, v28
  v_cmp_gt_u32 vcc, 4, v0
  v_lshlrev_b32 v8, 4, v0
  v_mov_b32 v9, 0x7fffffff
  v_cndmask_b32 v9, v9, v8, vcc
  v_mov_b32 v8, s63
  s_barrier
  ds_read_b64_tr_b16 v[96:97], v1 offset:40960
  ds_read_b64_tr_b16 v[98:99], v1 offset:41472
  ds_read_b128 v[32:35], v2 offset:0
  ds_read_b128 v[36:39], v2 offset:40960
  ds_read_b64_tr_b16 v[100:101], v1 offset:43008
  ds_read_b64_tr_b16 v[102:103], v1 offset:43520
  ds_read_b128 v[40:43], v3 offset:0
  ds_read_b128 v[44:47], v3 offset:40960
  ds_read_b64_tr_b16 v[104:105], v1 offset:45056
  ds_read_b64_tr_b16 v[106:107], v1 offset:45568
  ds_read_b128 v[80:83], v4 offset:0
  ds_read_b128 v[84:87], v4 offset:40960
  s_waitcnt lgkmcnt(8)
  v_mfma_f32_32x32x16_bf16 v[48:63], v[96:99], v[32:35], 0
  ds_read_b64_tr_b16 v[108:109], v1 offset:47104
  ds_read_b64_tr_b16 v[110:111], v1 offset:47616
  ds_read_b128 v[88:91], v5 offset:0
  ds_read_b128 v[92:95], v5 offset:40960
  v_mfma_f32_32x32x16_bf16 v[64:79], v[96:99], v[36:39], 0
  v_mfma_f32_16x16x32_bf16 v[16:19], v[28:31], v[96:99], 0
  s_waitcnt lgkmcnt(8)
  v_mfma_f32_32x32x16_bf16 v[48:63], v[100:103], v[40:43], v[48:63]
  s_waitcnt lgkmcnt(0)
  s_barrier
  ds_read_b64_tr_b16 v[112:113], v1 offset:57344
  ds_read_b64_tr_b16 v[114:115], v1 offset:57856
  ds_read_b128 v[32:35], v2 offset:4096
  ds_read_b128 v[36:39], v2 offset:45056
  v_mfma_f32_32x32x16_bf16 v[64:79], v[100:103], v[44:47], v[64:79]
  v_mfma_f32_16x16x32_bf16 v[16:19], v[28:31], v[100:103], v[16:19]
  v_mfma_f32_32x32x16_bf16 v[48:63], v[104:107], v[80:83], v[48:63]
  ds_read_b64_tr_b16 v[116:117], v1 offset:59392
  ds_read_b64_tr_b16 v[118:119], v1 offset:59904
  ds_read_b128 v[40:43], v3 offset:4096
  ds_read_b128 v[44:47], v3 offset:45056
  v_mfma_f32_32x32x16_bf16 v[64:79], v[104:107], v[84:87], v[64:79]
  v_mfma_f32_16x16x32_bf16 v[16:19], v[28:31], v[104:107], v[16:19]
  v_mfma_f32_32x32x16_bf16 v[48:63], v[108:111], v[88:91], v[48:63]
  ds_read_b64_tr_b16 v[120:121], v1 offset:61440
  ds_read_b64_tr_b16 v[122:123], v1 offset:61952
  ds_read_b128 v[80:83], v4 offset:4096
  ds_read_b128 v[84:87], v4 offset:45056
  v_mfma_f32_32x32x16_bf16 v[64:79], v[108:111], v[92:95], v[64:79]
  v_mfma_f32_16x16x32_bf16 v[16:19], v[28:31], v[108:111], v[16:19]
  s_waitcnt lgkmcnt(8)
  v_mfma_f32_32x32x16_bf16 v[48:63], v[112:115], v[32:35], v[48:63]
  ds_read_b64_tr_b16 v[124:125], v1 offset:63488
  ds_read_b64_tr_b16 v[126:127], v1 offset:64000
  ds_read_b128 v[88:91], v5 offset:4096
  ds_read_b128 v[92:95], v5 offset:45056
  v_mfma_f32_32x32x16_bf16 v[64:79], v[112:115], v[36:39], v[64:79]
  v_mfma_f32_16x16x32_bf16 v[16:19], v[28:31], v[112:115], v[16:19]
  s_waitcnt lgkmcnt(8)
  v_mfma_f32_32x32x16_bf16 v[48:63], v[116:119], v[40:43], v[48:63]
  s_waitcnt lgkmcnt(0)
  s_waitcnt vmcnt(0)
  s_barrier
  s_cmp_lg_u32 s60, 0
  s_cbranch_scc1 L_nofa_16
  buffer_store_dwordx4 v[8:11], v9, s[36:39], s4 offen sc1
L_nofa_16:
  ds_read_b64_tr_b16 v[128:129], v1 offset:0
  ds_read_b64_tr_b16 v[130:131], v1 offset:512
  ds_read_b128 v[32:35], v2 offset:8192
  ds_read_b128 v[36:39], v2 offset:49152
  v_mfma_f32_32x32x16_bf16 v[64:79], v[116:119], v[44:47], v[64:79]
  v_mfma_f32_16x16x32_bf16 v[16:19], v[28:31], v[116:119], v[16:19]
  v_mfma_f32_32x32x16_bf16 v[48:63], v[120:123], v[80:83], v[48:63]
  ds_read_b64_tr_b16 v[132:133], v1 offset:2048
  ds_read_b64_tr_b16 v[134:135], v1 offset:2560
  ds_read_b128 v[40:43], v3 offset:8192
  ds_read_b128 v[44:47], v3 offset:49152
  v_mfma_f32_32x32x16_bf16 v[64:79], v[120:123], v[84:87], v[64:79]
  v_mfma_f32_16x16x32_bf16 v[16:19], v[28:31], v[120:123], v[16:19]
  v_mfma_f32_32x32x16_bf16 v[48:63], v[124:127], v[88:91], v[48:63]
  ds_read_b64_tr_b16 v[136:137], v1 offset:4096
  ds_read_b64_tr_b16 v[138:139], v1 offset:4608
  ds_read_b128 v[80:83], v4 offset:8192
  ds_read_b128 v[84:87], v4 offset:49152
  v_mfma_f32_32x32x16_bf16 v[64:79], v[124:127], v[92:95], v[64:79]
  v_mfma_f32_16x16x32_bf16 v[16:19], v[28:31], v[124:127], v[16:19]
  s_waitcnt lgkmcnt(8)
  v_mfma_f32_32x32x16_bf16 v[48:63], v[128:131], v[32:35], v[48:63]
  ds_read_b64_tr_b16 v[140:141], v1 offset:6144
  ds_read_b64_tr_b16 v[142:143], v1 offset:6656
  ds_read_b128 v[88:91], v5 offset:8192
  ds_read_b128 v[92:95], v5 offset:49152
  v_mfma_f32_32x32x16_bf16 v[64:79], v[128:131], v[36:39], v[64:79]
  v_mfma_f32_16x16x32_bf16 v[16:19], v[28:31], v[128:131], v[16:19]
  s_waitcnt lgkmcnt(8)
  v_mfma_f32_32x32x16_bf16 v[48:63], v[132:135], v[40:43], v[48:63]
  s_waitcnt lgkmcnt(0)
  s_barrier
  ds_read_b64_tr_b16 v[144:145], v1 offset:16384
  ds_read_b64_tr_b16 v[146:147], v1 offset:16896
  ds_read_b128 v[32:35], v2 offset:12288
  ds_read_b128 v[36:39], v2 offset:53248
  v_mfma_f32_32x32x16_bf16 v[64:79], v[132:135], v[44:47], v[64:79]
  v_mfma_f32_16x16x32_bf16 v[16:19], v[28:31], v[132:135], v[16:19]
  v_mfma_f32_32x32x16_bf16 v[48:63], v[136:139], v[80:83], v[48:63]
  ds_read_b64_tr_b16 v[148:149], v1 offset:18432
  ds_read_b64_tr_b16 v[150:151], v1 offset:18944
  ds_read_b128 v[40:43], v3 offset:12288
  ds_read_b128 v[44:47], v3 offset:53248
  v_mfma_f32_32x32x16_bf16 v[64:79], v[136:139], v[84:87], v[64:79]
  v_mfma_f32_16x16x32_bf16 v[16:19], v[28:31], v[136:139], v[16:19]
  v_mfma_f32_32x32x16_bf16 v[48:63], v[140:143], v[88:91], v[48:63]
  ds_read_b64_tr_b16 v[152:153], v1 offset:20480
  ds_read_b64_tr_b16 v[154:155], v1 offset:20992
  ds_read_b128 v[80:83], v4 offset:12288
  ds_read_b128 v[84:87], v4 offset:53248
  v_mfma_f32_32x32x16_bf16 v[64:79], v[140:143], v[92:95], v[64:79]
  v_mfma_f32_16x16x32_bf16 v[16:19], v[28:31], v[140:143], v[16:19]
  s_waitcnt lgkmcnt(8)
  v_mfma_f32_32x32x16_bf16 v[48:63], v[144:147], v[32:35], v[48:63]
  ds_read_b64_tr_b16 v[156:157], v1 offset:22528
  ds_read_b64_tr_b16 v[158:159], v1 offset:23040
  ds_read_b128 v[88:91], v5 offset:12288
  ds_read_b128 v[92:95], v5 offset:53248
  v_mfma_f32_32x32x16_bf16 v[64:79], v[144:147], v[36:39], v[64:79]
  v_mfma_f32_16x16x32_bf16 v[16:19], v[28:31], v[144:147], v[16:19]
  s_waitcnt lgkmcnt(8)
  v_mfma_f32_32x32x16_bf16 v[48:63], v[148:151], v[40:43], v[48:63]
  s_waitcnt lgkmcnt(0)
  s_barrier
  ds_read_b64_tr_b16 v[160:161], v1 offset:40960
  ds_read_b64_tr_b16 v[162:163], v1 offset:41472
  ds_read_b128 v[32:35], v2 offset:16384
  ds_read_b128 v[36:39], v2 offset:57344
  v_mfma_f32_32x32x16_bf16 v[64:79], v[148:151], v[44:47], v[64:79]
  v_mfma_f32_16x16x32_bf16 v[16:19], v[28:31], v[148:151], v[16:19]
  v_mfma_f32_32x32x16_bf16 v[48:63], v[152:155], v[80:83], v[48:63]
  ds_read_b64_tr_b16 v[164:165], v1 offset:43008
  ds_read_b64_tr_b16 v[166:167], v1 offset:43520
  ds_read_b128 v[40:43], v3 offset:16384
  ds_read_b128 v[44:47], v3 offset:57344
  v_mfma_f32_32x32x16_bf16 v[64:79], v[152:155], v[84:87], v[64:79]
  v_mfma_f32_16x16x32_bf16 v[16:19], v[28:31], v[152:155], v[16:19]
  v_mfma_f32_32x32x16_bf16 v[48:63], v[156:159], v[88:91], v[48:63]
  ds_read_b64_tr_b16 v[168:169], v1 offset:45056
  ds_read_b64_tr_b16 v[170:171], v1 offset:45568
  ds_read_b128 v[80:83], v4 offset:16384
  ds_read_b128 v[84:87], v4 offset:57344
  v_mfma_f32_32x32x16_bf16 v[64:79], v[156:159], v[92:95], v[64:79]
  v_mfma_f32_16x16x32_bf16 v[16:19], v[28:31], v[156:159], v[16:19]
  s_waitcnt lgkmcnt(8)
  v_mfma_f32_32x32x16_bf16 v[48:63], v[160:163], v[32:35], v[48:63]
  ds_read_b64_tr_b16 v[172:173], v1 offset:47104
  ds_read_b64_tr_b16 v[174:175], v1 offset:47616
  ds_read_b128 v[88:91], v5 offset:16384
  ds_read_b128 v[92:95], v5 offset:57344
  v_mfma_f32_32x32x16_bf16 v[64:79], v[160:163], v[36:39], v[64:79]
  v_mfma_f32_16x16x32_bf16 v[16:19], v[28:31], v[160:163], v[16:19]
  s_waitcnt lgkmcnt(8)
  v_mfma_f32_32x32x16_bf16 v[48:63], v[164:167], v[40:43], v[48:63]
  v_add_u32 v2, 20480, v2
  v_add_u32 v3, 20480, v3
  v_add_u32 v4, 20480, v4
  v_add_u32 v5, 20480, v5
  s_waitcnt lgkmcnt(0)
  s_barrier
  ds_read_b64_tr_b16 v[176:177], v1 offset:57344
  ds_read_b64_tr_b16 v[178:179], v1 offset:57856
  ds_read_b128 v[32:35], v2 offset:0
  ds_read_b128 v[36:39], v2 offset:40960
  v_mfma_f32_32x32x16_bf16 v[64:79], v[164:167], v[44:47], v[64:79]
  v_mfma_f32_16x16x32_bf16 v[16:19], v[28:31], v[164:167], v[16:19]
  v_mfma_f32_32x32x16_bf16 v[48:63], v[168:171], v[80:83], v[48:63]
  ds_read_b64_tr_b16 v[180:181], v1 offset:59392
  ds_read_b64_tr_b16 v[182:183], v1 offset:59904
  ds_read_b128 v[40:43], v3 offset:0
  ds_read_b128 v[44:47], v3 offset:40960
  v_mfma_f32_32x32x16_bf16 v[64:79], v[168:171], v[84:87], v[64:79]
  v_mfma_f32_16x16x32_bf16 v[16:19], v[28:31], v[168:171], v[16:19]
  v_mfma_f32_32x32x16_bf16 v[48:63], v[172:175], v[88:91], v[48:63]
  ds_read_b64_tr_b16 v[184:185], v1 offset:61440
  ds_read_b64_tr_b16 v[186:187], v1 offset:61952
  ds_read_b128 v[80:83], v4 offset:0
  ds_read_b128 v[84:87], v4 offset:40960
  v_mfma_f32_32x32x16_bf16 v[64:79], v[172:175], v[92:95], v[64:79]
  v_mfma_f32_16x16x32_bf16 v[16:19], v[28:31], v[172:175], v[16:19]
  s_waitcnt lgkmcnt(8)
  v_mfma_f32_32x32x16_bf16 v[48:63], v[176:179], v[32:35], v[48:63]
  ds_read_b64_tr_b16 v[188:189], v1 offset:63488
  ds_read_b64_tr_b16 v[190:191], v1 offset:64000
  ds_read_b128 v[88:91], v5 offset:0
  ds_read_b128 v[92:95], v5 offset:40960
  v_mfma_f32_32x32x16_bf16 v[64:79], v[176:179], v[36:39], v[64:79]
  v_mfma_f32_16x16x32_bf16 v[16:19], v[28:31], v[176:179], v[16:19]
  s_waitcnt lgkmcnt(8)
  v_mfma_f32_32x32x16_bf16 v[48:63], v[180:183], v[40:43], v[48:63]
  s_waitcnt lgkmcnt(0)
  s_barrier
  ds_read_b64_tr_b16 v[192:193], v1 offset:0
  ds_read_b64_tr_b16 v[194:195], v1 offset:512
  ds_read_b128 v[32:35], v2 offset:4096
  ds_read_b128 v[36:39], v2 offset:45056
  v_mfma_f32_32x32x16_bf16 v[64:79], v[180:183], v[44:47], v[64:79]
  v_mfma_f32_16x16x32_bf16 v[16:19], v[28:31], v[180:183], v[16:19]
  v_mfma_f32_32x32x16_bf16 v[48:63], v[184:187], v[80:83], v[48:63]
  ds_read_b64_tr_b16 v[196:197], v1 offset:2048
  ds_read_b64_tr_b16 v[198:199], v1 offset:2560
  ds_read_b128 v[40:43], v3 offset:4096
  ds_read_b128 v[44:47], v3 offset:45056
  v_mfma_f32_32x32x16_bf16 v[64:79], v[184:187], v[84:87], v[64:79]
  v_mfma_f32_16x16x32_bf16 v[16:19], v[28:31], v[184:187], v[16:19]
  v_mfma_f32_32x32x16_bf16 v[48:63], v[188:191], v[88:91], v[48:63]
  ds_read_b64_tr_b16 v[200:201], v1 offset:4096
  ds_read_b64_tr_b16 v[202:203], v1 offset:4608
  ds_read_b128 v[80:83], v4 offset:4096
  ds_read_b128 v[84:87], v4 offset:45056
  v_mfma_f32_32x32x16_bf16 v[64:79], v[188:191], v[92:95], v[64:79]
  v_mfma_f32_16x16x32_bf16 v[16:19], v[28:31], v[188:191], v[16:19]
  s_waitcnt lgkmcnt(8)
  v_mfma_f32_32x32x16_bf16 v[48:63], v[192:195], v[32:35], v[48:63]
  ds_read_b64_tr_b16 v[204:205], v1 offset:6144
  ds_read_b64_tr_b16 v[206:207], v1 offset:6656
  ds_read_b128 v[88:91], v5 offset:4096
  ds_read_b128 v[92:95], v5 offset:45056
  v_mfma_f32_32x32x16_bf16 v[64:79], v[192:195], v[36:39], v[64:79]
  v_mfma_f32_16x16x32_bf16 v[16:19], v[28:31], v[192:195], v[16:19]
  s_waitcnt lgkmcnt(8)
  v_mfma_f32_32x32x16_bf16 v[48:63], v[196:199], v[40:43], v[48:63]
  s_waitcnt lgkmcnt(0)
  s_barrier
  ds_read_b64_tr_b16 v[208:209], v1 offset:16384
  ds_read_b64_tr_b16 v[210:211], v1 offset:16896
  ds_read_b128 v[32:35], v2 offset:8192
  ds_read_b128 v[36:39], v2 offset:49152
  v_mfma_f32_32x32x16_bf16 v[64:79], v[196:199], v[44:47], v[64:79]
  v_mfma_f32_16x16x32_bf16 v[16:19], v[28:31], v[196:199], v[16:19]
  v_mfma_f32_32x32x16_bf16 v[48:63], v[200:203], v[80:83], v[48:63]
  ds_read_b64_tr_b16 v[212:213], v1 offset:18432
  ds_read_b64_tr_b16 v[214:215], v1 offset:18944
  ds_read_b128 v[40:43], v3 offset:8192
  ds_read_b128 v[44:47], v3 offset:49152
  v_mfma_f32_32x32x16_bf16 v[64:79], v[200:203], v[84:87], v[64:79]
  v_mfma_f32_16x16x32_bf16 v[16:19], v[28:31], v[200:203], v[16:19]
  v_mfma_f32_32x32x16_bf16 v[48:63], v[204:207], v[88:91], v[48:63]
  ds_read_b64_tr_b16 v[216:217], v1 offset:20480
  ds_read_b64_tr_b16 v[218:219], v1 offset:20992
  ds_read_b128 v[80:83], v4 offset:8192
  ds_read_b128 v[84:87], v4 offset:49152
  v_mfma_f32_32x32x16_bf16 v[64:79], v[204:207], v[92:95], v[64:79]
  v_mfma_f32_16x16x32_bf16 v[16:19], v[28:31], v[204:207], v[16:19]
  s_waitcnt lgkmcnt(8)
  v_mfma_f32_32x32x16_bf16 v[48:63], v[208:211], v[32:35], v[48:63]
  ds_read_b64_tr_b16 v[220:221], v1 offset:22528
  ds_read_b64_tr_b16 v[222:223], v1 offset:23040
  ds_read_b128 v[88:91], v5 offset:8192
  ds_read_b128 v[92:95], v5 offset:49152
  v_mfma_f32_32x32x16_bf16 v[64:79], v[208:211], v[36:39], v[64:79]
  v_mfma_f32_16x16x32_bf16 v[16:19], v[28:31], v[208:211], v[16:19]
  s_waitcnt lgkmcnt(8)
  v_mfma_f32_32x32x16_bf16 v[48:63], v[212:215], v[40:43], v[48:63]
  s_waitcnt lgkmcnt(0)
  s_barrier
  ds_read_b64_tr_b16 v[224:225], v1 offset:40960
  ds_read_b64_tr_b16 v[226:227], v1 offset:41472
  ds_read_b128 v[32:35], v2 offset:12288
  ds_read_b128 v[36:39], v2 offset:53248
  v_mfma_f32_32x32x16_bf16 v[64:79], v[212:215], v[44:47], v[64:79]
  v_mfma_f32_16x16x32_bf16 v[16:19], v[28:31], v[212:215], v[16:19]
  v_mfma_f32_32x32x16_bf16 v[48:63], v[216:219], v[80:83], v[48:63]
  ds_read_b64_tr_b16 v[228:229], v1 offset:43008
  ds_read_b64_tr_b16 v[230:231], v1 offset:43520
  ds_read_b128 v[40:43], v3 offset:12288
  ds_read_b128 v[44:47], v3 offset:53248
  v_mfma_f32_32x32x16_bf16 v[64:79], v[216:219], v[84:87], v[64:79]
  v_mfma_f32_16x16x32_bf16 v[16:19], v[28:31], v[216:219], v[16:19]
  v_mfma_f32_32x32x16_bf16 v[48:63], v[220:223], v[88:91], v[48:63]
  ds_read_b64_tr_b16 v[232:233], v1 offset:45056
  ds_read_b64_tr_b16 v[234:235], v1 offset:45568
  ds_read_b128 v[80:83], v4 offset:12288
  ds_read_b128 v[84:87], v4 offset:53248
  v_mfma_f32_32x32x16_bf16 v[64:79], v[220:223], v[92:95], v[64:79]
  v_mfma_f32_16x16x32_bf16 v[16:19], v[28:31], v[220:223], v[16:19]
  s_waitcnt lgkmcnt(8)
  v_mfma_f32_32x32x16_bf16 v[48:63], v[224:227], v[32:35], v[48:63]
  ds_read_b64_tr_b16 v[236:237], v1 offset:47104
  ds_read_b64_tr_b16 v[238:239], v1 offset:47616
  ds_read_b128 v[88:91], v5 offset:12288
  ds_read_b128 v[92:95], v5 offset:53248
  v_mfma_f32_32x32x16_bf16 v[64:79], v[224:227], v[36:39], v[64:79]
  v_mfma_f32_16x16x32_bf16 v[16:19], v[28:31], v[224:227], v[16:19]
  s_waitcnt lgkmcnt(8)
  v_mfma_f32_32x32x16_bf16 v[48:63], v[228:231], v[40:43], v[48:63]
  s_barrier
  ds_read_b64_tr_b16 v[240:241], v1 offset:57344
  ds_read_b64_tr_b16 v[242:243], v1 offset:57856
  ds_read_b128 v[32:35], v2 offset:16384
  ds_read_b128 v[36:39], v2 offset:57344
  v_mfma_f32_32x32x16_bf16 v[64:79], v[228:231], v[44:47], v[64:79]
  v_mfma_f32_16x16x32_bf16 v[16:19], v[28:31], v[228:231], v[16:19]
  s_waitcnt lgkmcnt(8)
  v_mfma_f32_32x32x16_bf16 v[48:63], v[232:235], v[80:83], v[48:63]
  ds_read_b64_tr_b16 v[244:245], v1 offset:59392
  ds_read_b64_tr_b16 v[246:247], v1 offset:59904
  ds_read_b128 v[40:43], v3 offset:16384
  ds_read_b128 v[44:47], v3 offset:57344
  v_mfma_f32_32x32x16_bf16 v[64:79], v[232:235], v[84:87], v[64:79]
  v_mfma_f32_16x16x32_bf16 v[16:19], v[28:31], v[232:235], v[16:19]
  s_waitcnt lgkmcnt(8)
  v_mfma_f32_32x32x16_bf16 v[48:63], v[236:239], v[88:91], v[48:63]
  ds_read_b64_tr_b16 v[248:249], v1 offset:61440
  ds_read_b64_tr_b16 v[250:251], v1 offset:61952
  ds_read_b128 v[80:83], v4 offset:16384
  ds_read_b128 v[84:87], v4 offset:57344
  v_mfma_f32_32x32x16_bf16 v[64:79], v[236:239], v[92:95], v[64:79]
  v_mfma_f32_16x16x32_bf16 v[16:19], v[28:31], v[236:239], v[16:19]
  s_waitcnt lgkmcnt(8)
  v_mfma_f32_32x32x16_bf16 v[48:63], v[240:243], v[32:35], v[48:63]
  ds_read_b64_tr_b16 v[252:253], v1 offset:63488
  ds_read_b64_tr_b16 v[254:255], v1 offset:64000
  ds_read_b128 v[88:91], v5 offset:16384
  ds_read_b128 v[92:95], v5 offset:57344
  v_mfma_f32_32x32x16_bf16 v[64:79], v[240:243], v[36:39], v[64:79]
  v_mfma_f32_16x16x32_bf16 v[16:19], v[28:31], v[240:243], v[16:19]
  s_waitcnt lgkmcnt(8)
  v_mfma_f32_32x32x16_bf16 v[48:63], v[244:247], v[40:43], v[48:63]
  v_mfma_f32_32x32x16_bf16 v[64:79], v[244:247], v[44:47], v[64:79]
  v_mfma_f32_16x16x32_bf16 v[16:19], v[28:31], v[244:247], v[16:19]
  s_waitcnt lgkmcnt(4)
  v_mfma_f32_32x32x16_bf16 v[48:63], v[248:251], v[80:83], v[48:63]
  v_mfma_f32_32x32x16_bf16 v[64:79], v[248:251], v[84:87], v[64:79]
  v_mfma_f32_16x16x32_bf16 v[16:19], v[28:31], v[248:251], v[16:19]
  s_waitcnt lgkmcnt(0)
  v_mfma_f32_32x32x16_bf16 v[48:63], v[252:255], v[88:91], v[48:63]
  v_mfma_f32_32x32x16_bf16 v[64:79], v[252:255], v[92:95], v[64:79]
  v_mfma_f32_16x16x32_bf16 v[16:19], v[28:31], v[252:255], v[16:19]
  s_lshl_b32 s76, s65, 2
  s_add_u32 s76, s76, s60
  s_mul_i32 s78, s64, 1536
  s_add_u32 s78, s78, s76
  s_lshl_b32 s78, s78, 9
  s_add_u32 s78, s78, 5767168
  s_mul_i32 s79, s64, 72
  s_add_u32 s79, s79, s65
  s_lshl_b32 s79, s79, 7
  s_add_u32 s79, s79, 13631488
  s_add_u32 s34, s63, 3
  v_cvt_pk_bf16_f32 v11, v16, v16
  v_and_b32 v11, 0xffff0000, v11
  v_sub_f32 v11, v16, v11
  v_cvt_pk_bf16_f32 v12, v16, v11
  v_mov_b32 v11, 0
  s_waitcnt lgkmcnt(0)
  s_barrier
  v_add_u32 v2, 61440, v2
  v_add_u32 v3, 61440, v3
  v_add_u32 v4, 61440, v4
  v_add_u32 v5, 61440, v5
  ds_read_b128 v[32:35], v2 offset:0
  ds_read_b128 v[36:39], v3 offset:0
  ds_read_b128 v[40:43], v4 offset:0
  ds_read_b128 v[44:47], v5 offset:0
  ds_read_b128 v[28:31], v2 offset:4096
  s_waitcnt lgkmcnt(3)
  v_mfma_f32_32x32x16_bf16 v[80:95], v[96:99], v[32:35], 0
  ds_read_b32 v10, v6 offset:0
  ds_read_b128 v[32:35], v3 offset:4096
  v_mfma_f32_32x32x16_bf16 v[80:95], v[100:103], v[36:39], v[80:95]
  ds_read_b64 v[16:17], v6 offset:8
  ds_read_b128 v[36:39], v4 offset:4096
  s_waitcnt lgkmcnt(5)
  v_mfma_f32_32x32x16_bf16 v[80:95], v[104:107], v[40:43], v[80:95]
  ds_read_b128 v[40:43], v5 offset:4096
  v_mfma_f32_32x32x16_bf16 v[80:95], v[108:111], v[44:47], v[80:95]
  ds_read_b128 v[44:47], v2 offset:8192
  s_waitcnt lgkmcnt(4)
  v_mfma_f32_32x32x16_bf16 v[80:95], v[112:115], v[28:31], v[80:95]
  ds_read_b128 v[28:31], v3 offset:8192
  v_mfma_f32_32x32x16_bf16 v[80:95], v[116:119], v[32:35], v[80:95]
  s_waitcnt lgkmcnt(4)
  v_mfma_f32_32x32x16_bf16 v[48:63], v[12:15], v[10:13], v[48:63]
  ds_read_b128 v[32:35], v4 offset:8192
  s_waitcnt lgkmcnt(3)
  v_mfma_f32_32x32x16_bf16 v[80:95], v[120:123], v[36:39], v[80:95]
  ds_read_b128 v[36:39], v5 offset:8192
  v_mfma_f32_32x32x16_bf16 v[80:95], v[124:127], v[40:43], v[80:95]
  ds_read_b128 v[40:43], v2 offset:12288
  s_waitcnt lgkmcnt(3)
  v_mfma_f32_32x32x16_bf16 v[80:95], v[128:131], v[44:47], v[80:95]
  s_nop 3
  v_mul_f32 v20, v16, v48
  v_mul_f32 v21, v16, v49
  v_exp_f32 v20, v20
  ds_read_b128 v[44:47], v3 offset:12288
  v_mfma_f32_32x32x16_bf16 v[80:95], v[132:135], v[28:31], v[80:95]
  v_exp_f32 v21, v21
  v_fma_f32 v20, v20, v17, v17
  ds_read_b128 v[28:31], v4 offset:12288
  s_waitcnt lgkmcnt(3)
  v_mfma_f32_32x32x16_bf16 v[80:95], v[136:139], v[32:35], v[80:95]
  v_fma_f32 v21, v21, v17, v17
  v_rcp_f32 v20, v20
  v_mul_f32 v48, v48, v56
  ds_read_b128 v[32:35], v5 offset:12288
  v_mfma_f32_32x32x16_bf16 v[80:95], v[140:143], v[36:39], v[80:95]
  v_rcp_f32 v21, v21
  v_mul_f32 v49, v49, v57
  ds_read_b128 v[36:39], v2 offset:16384
  s_waitcnt lgkmcnt(3)
  v_mfma_f32_32x32x16_bf16 v[80:95], v[144:147], v[40:43], v[80:95]
  v_mul_f32 v48, v48, v20
  v_mul_f32 v49, v49, v21
  v_cvt_pk_bf16_f32 v56, v48, v49
  v_mul_f32 v22, v16, v50
  ds_read_b128 v[40:43], v3 offset:16384
  v_mfma_f32_32x32x16_bf16 v[80:95], v[148:151], v[44:47], v[80:95]
  v_mul_f32 v23, v16, v51
  v_exp_f32 v22, v22
  ds_read_b128 v[44:47], v4 offset:16384
  s_waitcnt lgkmcnt(3)
  v_mfma_f32_32x32x16_bf16 v[80:95], v[152:155], v[28:31], v[80:95]
  v_exp_f32 v23, v23
  v_fma_f32 v22, v22, v17, v17
  v_mul_f32 v50, v50, v58
  ds_read_b128 v[28:31], v5 offset:16384
  v_mfma_f32_32x32x16_bf16 v[80:95], v[156:159], v[32:35], v[80:95]
  v_fma_f32 v23, v23, v17, v17
  v_rcp_f32 v22, v22
  ds_read_b128 v[32:35], v2 offset:20480
  s_waitcnt lgkmcnt(3)
  v_mfma_f32_32x32x16_bf16 v[80:95], v[160:163], v[36:39], v[80:95]
  v_rcp_f32 v23, v23
  v_mul_f32 v51, v51, v59
  v_mul_f32 v50, v50, v22
  ds_read_b128 v[36:39], v3 offset:20480
  v_mfma_f32_32x32x16_bf16 v[80:95], v[164:167], v[40:43], v[80:95]
  v_mul_f32 v51, v51, v23
  v_cvt_pk_bf16_f32 v57, v50, v51
  v_mul_f32 v20, v16, v52
  ds_read_b128 v[40:43], v4 offset:20480
  s_waitcnt lgkmcnt(3)
  v_mfma_f32_32x32x16_bf16 v[80:95], v[168:171], v[44:47], v[80:95]
  v_mul_f32 v21, v16, v53
  v_exp_f32 v20, v20
  v_mul_f32 v52, v52, v60
  ds_read_b128 v[44:47], v5 offset:20480
  v_mfma_f32_32x32x16_bf16 v[80:95], v[172:175], v[28:31], v[80:95]
  v_exp_f32 v21, v21
  v_fma_f32 v20, v20, v17, v17
  ds_read_b128 v[28:31], v2 offset:24576
  s_waitcnt lgkmcnt(3)
  v_mfma_f32_32x32x16_bf16 v[80:95], v[176:179], v[32:35], v[80:95]
  v_fma_f32 v21, v21, v17, v17
  v_rcp_f32 v20, v20
  v_mul_f32 v53, v53, v61
  ds_read_b128 v[32:35], v3 offset:24576
  v_mfma_f32_32x32x16_bf16 v[80:95], v[180:183], v[36:39], v[80:95]
  v_rcp_f32 v21, v21
  v_mul_f32 v52, v52, v20
  ds_read_b128 v[36:39], v4 offset:24576
  s_waitcnt lgkmcnt(3)
  v_mfma_f32_32x32x16_bf16 v[80:95], v[184:187], v[40:43], v[80:95]
  ds_read_b32 v10, v6 offset:512
  v_mul_f32 v53, v53, v21
  v_cvt_pk_bf16_f32 v58, v52, v53
  v_mul_f32 v22, v16, v54
  ds_read_b128 v[40:43], v5 offset:24576
  v_mfma_f32_32x32x16_bf16 v[80:95], v[188:191], v[44:47], v[80:95]
  ds_read_b64 v[18:19], v6 offset:520
  v_mul_f32 v23, v16, v55
  ds_read_b128 v[44:47], v2 offset:28672
  s_waitcnt lgkmcnt(5)
  v_mfma_f32_32x32x16_bf16 v[80:95], v[192:195], v[28:31], v[80:95]
  v_exp_f32 v22, v22
  v_exp_f32 v23, v23
  ds_read_b128 v[28:31], v3 offset:28672
  v_mfma_f32_32x32x16_bf16 v[80:95], v[196:199], v[32:35], v[80:95]
  v_fma_f32 v22, v22, v17, v17
  v_fma_f32 v23, v23, v17, v17
  v_mul_f32 v54, v54, v62
  ds_read_b128 v[32:35], v4 offset:28672
  s_waitcnt lgkmcnt(4)
  v_mfma_f32_32x32x16_bf16 v[80:95], v[200:203], v[36:39], v[80:95]
  s_waitcnt lgkmcnt(3)
  v_mfma_f32_32x32x16_bf16 v[64:79], v[12:15], v[10:13], v[64:79]
  v_rcp_f32 v22, v22
  v_rcp_f32 v23, v23
  ds_read_b128 v[36:39], v5 offset:28672
  v_mfma_f32_32x32x16_bf16 v[80:95], v[204:207], v[40:43], v[80:95]
  v_mul_f32 v55, v55, v63
  v_mul_f32 v54, v54, v22
  v_mul_f32 v55, v55, v23
  ds_read_b128 v[40:43], v2 offset:32768
  s_waitcnt lgkmcnt(3)
  v_mfma_f32_32x32x16_bf16 v[80:95], v[208:211], v[44:47], v[80:95]
  v_cvt_pk_bf16_f32 v59, v54, v55
  ds_read_b128 v[44:47], v3 offset:32768
  v_mfma_f32_32x32x16_bf16 v[80:95], v[212:215], v[28:31], v[80:95]
  v_mul_f32 v20, v18, v64
  v_mul_f32 v21, v18, v65
  v_mul_f32 v64, v64, v72
  ds_read_b128 v[28:31], v4 offset:32768
  s_waitcnt lgkmcnt(3)
  v_mfma_f32_32x32x16_bf16 v[80:95], v[216:219], v[32:35], v[80:95]
  v_exp_f32 v20, v20
  v_exp_f32 v21, v21
  ds_read_b128 v[32:35], v5 offset:32768
  v_mfma_f32_32x32x16_bf16 v[80:95], v[220:223], v[36:39], v[80:95]
  v_fma_f32 v20, v20, v19, v19
  v_fma_f32 v21, v21, v19, v19
  v_mul_f32 v65, v65, v73
  ds_read_b128 v[36:39], v2 offset:36864
  s_waitcnt lgkmcnt(3)
  v_mfma_f32_32x32x16_bf16 v[80:95], v[224:227], v[40:43], v[80:95]
  v_rcp_f32 v20, v20
  v_rcp_f32 v21, v21
  ds_read_b128 v[40:43], v3 offset:36864
  v_mfma_f32_32x32x16_bf16 v[80:95], v[228:231], v[44:47], v[80:95]
  v_mul_f32 v64, v64, v20
  v_mul_f32 v65, v65, v21
  v_cvt_pk_bf16_f32 v72, v64, v65
  ds_read_b128 v[44:47], v4 offset:36864
  s_waitcnt lgkmcnt(3)
  v_mfma_f32_32x32x16_bf16 v[80:95], v[232:235], v[28:31], v[80:95]
  v_mul_f32 v22, v18, v66
  v_mul_f32 v23, v18, v67
  v_exp_f32 v22, v22
  ds_read_b128 v[28:31], v5 offset:36864
  v_mfma_f32_32x32x16_bf16 v[80:95], v[236:239], v[32:35], v[80:95]
  s_add_u32 s76, s78, 0
  buffer_store_dwordx4 v[56:59], v7, s[36:39], s76 offen sc1
  s_barrier
  v_subrev_u32 v2, 81920, v2
  v_subrev_u32 v3, 81920, v3
  v_subrev_u32 v4, 81920, v4
  v_subrev_u32 v5, 81920, v5
  ds_read_b128 v[32:35], v2 offset:0
  s_waitcnt lgkmcnt(3)
  v_mfma_f32_32x32x16_bf16 v[80:95], v[240:243], v[36:39], v[80:95]
  v_exp_f32 v23, v23
  v_fma_f32 v22, v22, v19, v19
  ds_read_b128 v[36:39], v3 offset:0
  v_mfma_f32_32x32x16_bf16 v[80:95], v[244:247], v[40:43], v[80:95]
  v_fma_f32 v23, v23, v19, v19
  v_mul_f32 v66, v66, v74
  ds_read_b128 v[40:43], v4 offset:0
  s_waitcnt lgkmcnt(3)
  v_mfma_f32_32x32x16_bf16 v[80:95], v[248:251], v[44:47], v[80:95]
  v_rcp_f32 v22, v22
  v_mul_f32 v67, v67, v75
  ds_read_b128 v[44:47], v5 offset:0
  v_mfma_f32_32x32x16_bf16 v[80:95], v[252:255], v[28:31], v[80:95]
  v_rcp_f32 v23, v23
  ds_read_b128 v[28:31], v2 offset:4096
  s_waitcnt lgkmcnt(3)
  v_mfma_f32_32x32x16_bf16 v[48:63], v[96:99], v[32:35], 0
  v_mul_f32 v66, v66, v22
  v_mul_f32 v67, v67, v23
  v_cvt_pk_bf16_f32 v73, v66, v67
  ds_read_b128 v[32:35], v3 offset:4096
  v_mfma_f32_32x32x16_bf16 v[48:63], v[100:103], v[36:39], v[48:63]
  v_mul_f32 v20, v18, v68
  v_mul_f32 v21, v18, v69
  ds_read_b128 v[36:39], v4 offset:4096
  s_waitcnt lgkmcnt(3)
  v_mfma_f32_32x32x16_bf16 v[48:63], v[104:107], v[40:43], v[48:63]
  v_exp_f32 v20, v20
  v_mul_f32 v68, v68, v76
  ds_read_b128 v[40:43], v5 offset:4096
  v_mfma_f32_32x32x16_bf16 v[48:63], v[108:111], v[44:47], v[48:63]
  v_exp_f32 v21, v21
  ds_read_b128 v[44:47], v2 offset:8192
  s_waitcnt lgkmcnt(3)
  v_mfma_f32_32x32x16_bf16 v[48:63], v[112:115], v[28:31], v[48:63]
  v_fma_f32 v20, v20, v19, v19
  v_fma_f32 v21, v21, v19, v19
  v_mul_f32 v69, v69, v77
  ds_read_b128 v[28:31], v3 offset:8192
  v_mfma_f32_32x32x16_bf16 v[48:63], v[116:119], v[32:35], v[48:63]
  v_rcp_f32 v20, v20
  ds_read_b128 v[32:35], v4 offset:8192
  s_waitcnt lgkmcnt(3)
  v_mfma_f32_32x32x16_bf16 v[48:63], v[120:123], v[36:39], v[48:63]
  v_rcp_f32 v21, v21
  v_mul_f32 v68, v68, v20
  ds_read_b128 v[36:39], v5 offset:8192
  v_mfma_f32_32x32x16_bf16 v[48:63], v[124:127], v[40:43], v[48:63]
  ds_read_b32 v10, v6 offset:1024
  v_mul_f32 v69, v69, v21
  ds_read_b128 v[40:43], v2 offset:12288
  s_waitcnt lgkmcnt(4)
  v_mfma_f32_32x32x16_bf16 v[48:63], v[128:131], v[44:47], v[48:63]
  ds_read_b64 v[16:17], v6 offset:1032
  v_cvt_pk_bf16_f32 v74, v68, v69
  ds_read_b128 v[44:47], v3 offset:12288
  v_mfma_f32_32x32x16_bf16 v[48:63], v[132:135], v[28:31], v[48:63]
  v_mul_f32 v22, v18, v70
  v_mul_f32 v23, v18, v71
  ds_read_b128 v[28:31], v4 offset:12288
  s_waitcnt lgkmcnt(5)
  v_mfma_f32_32x32x16_bf16 v[48:63], v[136:139], v[32:35], v[48:63]
  v_exp_f32 v22, v22
  v_mul_f32 v70, v70, v78
  ds_read_b128 v[32:35], v5 offset:12288
  v_mfma_f32_32x32x16_bf16 v[48:63], v[140:143], v[36:39], v[48:63]
  s_waitcnt lgkmcnt(3)
  v_mfma_f32_32x32x16_bf16 v[80:95], v[12:15], v[10:13], v[80:95]
  v_exp_f32 v23, v23
  ds_read_b128 v[36:39], v2 offset:16384
  s_waitcnt lgkmcnt(3)
  v_mfma_f32_32x32x16_bf16 v[48:63], v[144:147], v[40:43], v[48:63]
  v_fma_f32 v22, v22, v19, v19
  v_fma_f32 v23, v23, v19, v19
  v_mul_f32 v71, v71, v79
  ds_read_b128 v[40:43], v3 offset:16384
  v_mfma_f32_32x32x16_bf16 v[48:63], v[148:151], v[44:47], v[48:63]
  v_rcp_f32 v22, v22
  ds_read_b128 v[44:47], v4 offset:16384
  s_waitcnt lgkmcnt(3)
  v_mfma_f32_32x32x16_bf16 v[48:63], v[152:155], v[28:31], v[48:63]
  v_rcp_f32 v23, v23
  v_mul_f32 v70, v70, v22
  ds_read_b128 v[28:31], v5 offset:16384
  v_mfma_f32_32x32x16_bf16 v[48:63], v[156:159], v[32:35], v[48:63]
  v_mul_f32 v71, v71, v23
  v_cvt_pk_bf16_f32 v75, v70, v71
  ds_read_b128 v[32:35], v2 offset:20480
  s_waitcnt lgkmcnt(3)
  v_mfma_f32_32x32x16_bf16 v[48:63], v[160:163], v[36:39], v[48:63]
  v_mul_f32 v20, v16, v80
  v_mul_f32 v21, v16, v81
  v_mul_f32 v80, v80, v88
  ds_read_b128 v[36:39], v3 offset:20480
  v_mfma_f32_32x32x16_bf16 v[48:63], v[164:167], v[40:43], v[48:63]
  v_exp_f32 v20, v20
  ds_read_b128 v[40:43], v4 offset:20480
  s_waitcnt lgkmcnt(3)
  v_mfma_f32_32x32x16_bf16 v[48:63], v[168:171], v[44:47], v[48:63]
  v_exp_f32 v21, v21
  v_fma_f32 v20, v20, v17, v17
  ds_read_b128 v[44:47], v5 offset:20480
  v_mfma_f32_32x32x16_bf16 v[48:63], v[172:175], v[28:31], v[48:63]
  v_fma_f32 v21, v21, v17, v17
  v_mul_f32 v81, v81, v89
  ds_read_b128 v[28:31], v2 offset:24576
  s_waitcnt lgkmcnt(3)
  v_mfma_f32_32x32x16_bf16 v[48:63], v[176:179], v[32:35], v[48:63]
  v_rcp_f32 v20, v20
  v_mul_f32 v22, v16, v82
  ds_read_b128 v[32:35], v3 offset:24576
  v_mfma_f32_32x32x16_bf16 v[48:63], v[180:183], v[36:39], v[48:63]
  v_rcp_f32 v21, v21
  ds_read_b128 v[36:39], v4 offset:24576
  s_waitcnt lgkmcnt(3)
  v_mfma_f32_32x32x16_bf16 v[48:63], v[184:187], v[40:43], v[48:63]
  v_mul_f32 v80, v80, v20
  v_mul_f32 v81, v81, v21
  v_cvt_pk_bf16_f32 v88, v80, v81
  ds_read_b128 v[40:43], v5 offset:24576
  v_mfma_f32_32x32x16_bf16 v[48:63], v[188:191], v[44:47], v[48:63]
  v_mul_f32 v23, v16, v83
  v_mul_f32 v82, v82, v90
  ds_read_b128 v[44:47], v2 offset:28672
  s_waitcnt lgkmcnt(3)
  v_mfma_f32_32x32x16_bf16 v[48:63], v[192:195], v[28:31], v[48:63]
  v_exp_f32 v22, v22
  v_mul_f32 v83, v83, v91
  ds_read_b128 v[28:31], v3 offset:28672
  v_mfma_f32_32x32x16_bf16 v[48:63], v[196:199], v[32:35], v[48:63]
  v_exp_f32 v23, v23
  ds_read_b128 v[32:35], v4 offset:28672
  s_waitcnt lgkmcnt(3)
  v_mfma_f32_32x32x16_bf16 v[48:63], v[200:203], v[36:39], v[48:63]
  v_fma_f32 v22, v22, v17, v17
  v_fma_f32 v23, v23, v17, v17
  v_mul_f32 v20, v16, v84
  ds_read_b128 v[36:39], v5 offset:28672
  v_mfma_f32_32x32x16_bf16 v[48:63], v[204:207], v[40:43], v[48:63]
  v_rcp_f32 v22, v22
  ds_read_b128 v[40:43], v2 offset:32768
  s_waitcnt lgkmcnt(3)
  v_mfma_f32_32x32x16_bf16 v[48:63], v[208:211], v[44:47], v[48:63]
  v_rcp_f32 v23, v23
  v_mul_f32 v82, v82, v22
  ds_read_b128 v[44:47], v3 offset:32768
  v_mfma_f32_32x32x16_bf16 v[48:63], v[212:215], v[28:31], v[48:63]
  v_mul_f32 v83, v83, v23
  v_cvt_pk_bf16_f32 v89, v82, v83
  ds_read_b128 v[28:31], v4 offset:32768
  s_waitcnt lgkmcnt(3)
  v_mfma_f32_32x32x16_bf16 v[48:63], v[216:219], v[32:35], v[48:63]
  v_mul_f32 v21, v16, v85
  v_exp_f32 v20, v20
  ds_read_b128 v[32:35], v5 offset:32768
  v_mfma_f32_32x32x16_bf16 v[48:63], v[220:223], v[36:39], v[48:63]
  v_exp_f32 v21, v21
  ds_read_b128 v[36:39], v2 offset:36864
  s_waitcnt lgkmcnt(3)
  v_mfma_f32_32x32x16_bf16 v[48:63], v[224:227], v[40:43], v[48:63]
  v_fma_f32 v20, v20, v17, v17
  v_fma_f32 v21, v21, v17, v17
  v_mul_f32 v84, v84, v92
  ds_read_b128 v[40:43], v3 offset:36864
  v_mfma_f32_32x32x16_bf16 v[48:63], v[228:231], v[44:47], v[48:63]
  v_rcp_f32 v20, v20
  ds_read_b128 v[44:47], v4 offset:36864
  s_waitcnt lgkmcnt(3)
  v_mfma_f32_32x32x16_bf16 v[48:63], v[232:235], v[28:31], v[48:63]
  v_rcp_f32 v21, v21
  v_mul_f32 v85, v85, v93
  ds_read_b128 v[28:31], v5 offset:36864
  v_mfma_f32_32x32x16_bf16 v[48:63], v[236:239], v[32:35], v[48:63]
  s_add_u32 s76, s78, 98304
  buffer_store_dwordx4 v[72:75], v7, s[36:39], s76 offen sc1
  s_barrier
  v_add_u32 v2, 40960, v2
  v_add_u32 v3, 40960, v3
  v_add_u32 v4, 40960, v4
  v_add_u32 v5, 40960, v5
  ds_read_b128 v[32:35], v2 offset:0
  s_waitcnt lgkmcnt(3)
  v_mfma_f32_32x32x16_bf16 v[48:63], v[240:243], v[36:39], v[48:63]
  v_mul_f32 v84, v84, v20
  v_mul_f32 v85, v85, v21
  v_cvt_pk_bf16_f32 v90, v84, v85
  ds_read_b128 v[36:39], v3 offset:0
  v_mfma_f32_32x32x16_bf16 v[48:63], v[244:247], v[40:43], v[48:63]
  v_mul_f32 v22, v16, v86
  v_mul_f32 v23, v16, v87
  ds_read_b128 v[40:43], v4 offset:0
  s_waitcnt lgkmcnt(3)
  v_mfma_f32_32x32x16_bf16 v[48:63], v[248:251], v[44:47], v[48:63]
  v_exp_f32 v22, v22
  v_mul_f32 v86, v86, v94
  ds_read_b128 v[44:47], v5 offset:0
  v_mfma_f32_32x32x16_bf16 v[48:63], v[252:255], v[28:31], v[48:63]
  v_exp_f32 v23, v23
  ds_read_b128 v[28:31], v2 offset:4096
  s_waitcnt lgkmcnt(3)
  v_mfma_f32_32x32x16_bf16 v[64:79], v[96:99], v[32:35], 0
  ds_read_b32 v10, v6 offset:1536
  v_fma_f32 v22, v22, v17, v17
  v_fma_f32 v23, v23, v17, v17
  ds_read_b128 v[32:35], v3 offset:4096
  v_mfma_f32_32x32x16_bf16 v[64:79], v[100:103], v[36:39], v[64:79]
  ds_read_b64 v[18:19], v6 offset:1544
  ds_read_b128 v[36:39], v4 offset:4096
  s_waitcnt lgkmcnt(5)
  v_mfma_f32_32x32x16_bf16 v[64:79], v[104:107], v[40:43], v[64:79]
  v_rcp_f32 v22, v22
  v_mul_f32 v87, v87, v95
  ds_read_b128 v[40:43], v5 offset:4096
  v_mfma_f32_32x32x16_bf16 v[64:79], v[108:111], v[44:47], v[64:79]
  v_rcp_f32 v23, v23
  ds_read_b128 v[44:47], v2 offset:8192
  s_waitcnt lgkmcnt(4)
  v_mfma_f32_32x32x16_bf16 v[64:79], v[112:115], v[28:31], v[64:79]
  v_mul_f32 v86, v86, v22
  v_mul_f32 v87, v87, v23
  v_cvt_pk_bf16_f32 v91, v86, v87
  ds_read_b128 v[28:31], v3 offset:8192
  v_mfma_f32_32x32x16_bf16 v[64:79], v[116:119], v[32:35], v[64:79]
  s_waitcnt lgkmcnt(4)
  v_mfma_f32_32x32x16_bf16 v[48:63], v[12:15], v[10:13], v[48:63]
  ds_read_b128 v[32:35], v4 offset:8192
  s_waitcnt lgkmcnt(3)
  v_mfma_f32_32x32x16_bf16 v[64:79], v[120:123], v[36:39], v[64:79]
  ds_read_b128 v[36:39], v5 offset:8192
  v_mfma_f32_32x32x16_bf16 v[64:79], v[124:127], v[40:43], v[64:79]
  ds_read_b128 v[40:43], v2 offset:12288
  s_waitcnt lgkmcnt(3)
  v_mfma_f32_32x32x16_bf16 v[64:79], v[128:131], v[44:47], v[64:79]
  s_nop 3
  v_mul_f32 v20, v18, v48
  v_mul_f32 v21, v18, v49
  v_mul_f32 v48, v48, v56
  ds_read_b128 v[44:47], v3 offset:12288
  v_mfma_f32_32x32x16_bf16 v[64:79], v[132:135], v[28:31], v[64:79]
  v_exp_f32 v20, v20
  ds_read_b128 v[28:31], v4 offset:12288
  s_waitcnt lgkmcnt(3)
  v_mfma_f32_32x32x16_bf16 v[64:79], v[136:139], v[32:35], v[64:79]
  v_exp_f32 v21, v21
  v_fma_f32 v20, v20, v19, v19
  ds_read_b128 v[32:35], v5 offset:12288
  v_mfma_f32_32x32x16_bf16 v[64:79], v[140:143], v[36:39], v[64:79]
  v_fma_f32 v21, v21, v19, v19
  v_mul_f32 v49, v49, v57
  ds_read_b128 v[36:39], v2 offset:16384
  s_waitcnt lgkmcnt(3)
  v_mfma_f32_32x32x16_bf16 v[64:79], v[144:147], v[40:43], v[64:79]
  v_rcp_f32 v20, v20
  v_mul_f32 v22, v18, v50
  ds_read_b128 v[40:43], v3 offset:16384
  v_mfma_f32_32x32x16_bf16 v[64:79], v[148:151], v[44:47], v[64:79]
  v_rcp_f32 v21, v21
  ds_read_b128 v[44:47], v4 offset:16384
  s_waitcnt lgkmcnt(3)
  v_mfma_f32_32x32x16_bf16 v[64:79], v[152:155], v[28:31], v[64:79]
  v_mul_f32 v48, v48, v20
  v_mul_f32 v49, v49, v21
  v_cvt_pk_bf16_f32 v56, v48, v49
  ds_read_b128 v[28:31], v5 offset:16384
  v_mfma_f32_32x32x16_bf16 v[64:79], v[156:159], v[32:35], v[64:79]
  v_mul_f32 v23, v18, v51
  v_mul_f32 v50, v50, v58
  ds_read_b128 v[32:35], v2 offset:20480
  s_waitcnt lgkmcnt(3)
  v_mfma_f32_32x32x16_bf16 v[64:79], v[160:163], v[36:39], v[64:79]
  v_exp_f32 v22, v22
  v_mul_f32 v51, v51, v59
  ds_read_b128 v[36:39], v3 offset:20480
  v_mfma_f32_32x32x16_bf16 v[64:79], v[164:167], v[40:43], v[64:79]
  v_exp_f32 v23, v23
  ds_read_b128 v[40:43], v4 offset:20480
  s_waitcnt lgkmcnt(3)
  v_mfma_f32_32x32x16_bf16 v[64:79], v[168:171], v[44:47], v[64:79]
  v_fma_f32 v22, v22, v19, v19
  v_fma_f32 v23, v23, v19, v19
  v_mul_f32 v20, v18, v52
  ds_read_b128 v[44:47], v5 offset:20480
  v_mfma_f32_32x32x16_bf16 v[64:79], v[172:175], v[28:31], v[64:79]
  v_rcp_f32 v22, v22
  ds_read_b128 v[28:31], v2 offset:24576
  s_waitcnt lgkmcnt(3)
  v_mfma_f32_32x32x16_bf16 v[64:79], v[176:179], v[32:35], v[64:79]
  v_rcp_f32 v23, v23
  v_mul_f32 v50, v50, v22
  ds_read_b128 v[32:35], v3 offset:24576
  v_mfma_f32_32x32x16_bf16 v[64:79], v[180:183], v[36:39], v[64:79]
  v_mul_f32 v51, v51, v23
  v_cvt_pk_bf16_f32 v57, v50, v51
  ds_read_b128 v[36:39], v4 offset:24576
  s_waitcnt lgkmcnt(3)
  v_mfma_f32_32x32x16_bf16 v[64:79], v[184:187], v[40:43], v[64:79]
  v_mul_f32 v21, v18, v53
  v_exp_f32 v20, v20
  ds_read_b128 v[40:43], v5 offset:24576
  v_mfma_f32_32x32x16_bf16 v[64:79], v[188:191], v[44:47], v[64:79]
  v_exp_f32 v21, v21
  ds_read_b128 v[44:47], v2 offset:28672
  s_waitcnt lgkmcnt(3)
  v_mfma_f32_32x32x16_bf16 v[64:79], v[192:195], v[28:31], v[64:79]
  v_fma_f32 v20, v20, v19, v19
  v_fma_f32 v21, v21, v19, v19
  v_mul_f32 v52, v52, v60
  ds_read_b128 v[28:31], v3 offset:28672
  v_mfma_f32_32x32x16_bf16 v[64:79], v[196:199], v[32:35], v[64:79]
  v_rcp_f32 v20, v20
  ds_read_b128 v[32:35], v4 offset:28672
  s_waitcnt lgkmcnt(3)
  v_mfma_f32_32x32x16_bf16 v[64:79], v[200:203], v[36:39], v[64:79]
  v_rcp_f32 v21, v21
  v_mul_f32 v53, v53, v61
  ds_read_b128 v[36:39], v5 offset:28672
  v_mfma_f32_32x32x16_bf16 v[64:79], v[204:207], v[40:43], v[64:79]
  v_mul_f32 v52, v52, v20
  v_mul_f32 v53, v53, v21
  ds_read_b128 v[40:43], v2 offset:32768
  s_waitcnt lgkmcnt(3)
  v_mfma_f32_32x32x16_bf16 v[64:79], v[208:211], v[44:47], v[64:79]
  v_cvt_pk_bf16_f32 v58, v52, v53
  v_mul_f32 v22, v18, v54
  v_mul_f32 v23, v18, v55
  ds_read_b128 v[44:47], v3 offset:32768
  v_mfma_f32_32x32x16_bf16 v[64:79], v[212:215], v[28:31], v[64:79]
  v_exp_f32 v22, v22
  ds_read_b128 v[28:31], v4 offset:32768
  s_waitcnt lgkmcnt(3)
  v_mfma_f32_32x32x16_bf16 v[64:79], v[216:219], v[32:35], v[64:79]
  v_exp_f32 v23, v23
  v_fma_f32 v22, v22, v19, v19
  ds_read_b128 v[32:35], v5 offset:32768
  v_mfma_f32_32x32x16_bf16 v[64:79], v[220:223], v[36:39], v[64:79]
  v_fma_f32 v23, v23, v19, v19
  v_mul_f32 v54, v54, v62
  ds_read_b128 v[36:39], v2 offset:36864
  s_waitcnt lgkmcnt(3)
  v_mfma_f32_32x32x16_bf16 v[64:79], v[224:227], v[40:43], v[64:79]
  v_rcp_f32 v22, v22
  v_mul_f32 v55, v55, v63
  ds_read_b128 v[40:43], v3 offset:36864
  v_mfma_f32_32x32x16_bf16 v[64:79], v[228:231], v[44:47], v[64:79]
  v_rcp_f32 v23, v23
  ds_read_b128 v[44:47], v4 offset:36864
  s_waitcnt lgkmcnt(3)
  v_mfma_f32_32x32x16_bf16 v[64:79], v[232:235], v[28:31], v[64:79]
  v_mul_f32 v54, v54, v22
  v_mul_f32 v55, v55, v23
  v_cvt_pk_bf16_f32 v59, v54, v55
  ds_read_b128 v[28:31], v5 offset:36864
  v_mfma_f32_32x32x16_bf16 v[64:79], v[236:239], v[32:35], v[64:79]
  s_add_u32 s76, s78, 196608
  buffer_store_dwordx4 v[88:91], v7, s[36:39], s76 offen sc1
  s_add_u32 s76, s78, 294912
  buffer_store_dwordx4 v[56:59], v7, s[36:39], s76 offen sc1
  s_barrier
  v_add_u32 v2, 40960, v2
  v_add_u32 v3, 40960, v3
  v_add_u32 v4, 40960, v4
  v_add_u32 v5, 40960, v5
  ds_read_b128 v[32:35], v2 offset:0
  s_waitcnt lgkmcnt(3)
  v_mfma_f32_32x32x16_bf16 v[64:79], v[240:243], v[36:39], v[64:79]
  ds_read_b128 v[36:39], v3 offset:0
  v_mfma_f32_32x32x16_bf16 v[64:79], v[244:247], v[40:43], v[64:79]
  ds_read_b128 v[40:43], v4 offset:0
  s_waitcnt lgkmcnt(3)
  v_mfma_f32_32x32x16_bf16 v[64:79], v[248:251], v[44:47], v[64:79]
  ds_read_b128 v[44:47], v5 offset:0
  v_mfma_f32_32x32x16_bf16 v[64:79], v[252:255], v[28:31], v[64:79]
  ds_read_b128 v[28:31], v2 offset:4096
  s_waitcnt lgkmcnt(3)
  v_mfma_f32_32x32x16_bf16 v[80:95], v[96:99], v[32:35], 0
  ds_read_b32 v10, v6 offset:2048
  ds_read_b128 v[32:35], v3 offset:4096
  v_mfma_f32_32x32x16_bf16 v[80:95], v[100:103], v[36:39], v[80:95]
  ds_read_b64 v[16:17], v6 offset:2056
  ds_read_b128 v[36:39], v4 offset:4096
  s_waitcnt lgkmcnt(5)
  v_mfma_f32_32x32x16_bf16 v[80:95], v[104:107], v[40:43], v[80:95]
  ds_read_b128 v[40:43], v5 offset:4096
  v_mfma_f32_32x32x16_bf16 v[80:95], v[108:111], v[44:47], v[80:95]
  ds_read_b128 v[44:47], v2 offset:8192
  s_waitcnt lgkmcnt(4)
  v_mfma_f32_32x32x16_bf16 v[80:95], v[112:115], v[28:31], v[80:95]
  ds_read_b128 v[28:31], v3 offset:8192
  v_mfma_f32_32x32x16_bf16 v[80:95], v[116:119], v[32:35], v[80:95]
  s_waitcnt lgkmcnt(4)
  v_mfma_f32_32x32x16_bf16 v[64:79], v[12:15], v[10:13], v[64:79]
  ds_read_b128 v[32:35], v4 offset:8192
  s_waitcnt lgkmcnt(3)
  v_mfma_f32_32x32x16_bf16 v[80:95], v[120:123], v[36:39], v[80:95]
  ds_read_b128 v[36:39], v5 offset:8192
  v_mfma_f32_32x32x16_bf16 v[80:95], v[124:127], v[40:43], v[80:95]
  ds_read_b128 v[40:43], v2 offset:12288
  s_waitcnt lgkmcnt(3)
  v_mfma_f32_32x32x16_bf16 v[80:95], v[128:131], v[44:47], v[80:95]
  s_nop 3
  v_mul_f32 v20, v16, v64
  v_mul_f32 v21, v16, v65
  v_mul_f32 v64, v64, v72
  ds_read_b128 v[44:47], v3 offset:12288
  v_mfma_f32_32x32x16_bf16 v[80:95], v[132:135], v[28:31], v[80:95]
  v_exp_f32 v20, v20
  ds_read_b128 v[28:31], v4 offset:12288
  s_waitcnt lgkmcnt(3)
  v_mfma_f32_32x32x16_bf16 v[80:95], v[136:139], v[32:35], v[80:95]
  v_exp_f32 v21, v21
  v_fma_f32 v20, v20, v17, v17
  ds_read_b128 v[32:35], v5 offset:12288
  v_mfma_f32_32x32x16_bf16 v[80:95], v[140:143], v[36:39], v[80:95]
  v_fma_f32 v21, v21, v17, v17
  v_mul_f32 v65, v65, v73
  ds_read_b128 v[36:39], v2 offset:16384
  s_waitcnt lgkmcnt(3)
  v_mfma_f32_32x32x16_bf16 v[80:95], v[144:147], v[40:43], v[80:95]
  v_rcp_f32 v20, v20
  v_mul_f32 v22, v16, v66
  ds_read_b128 v[40:43], v3 offset:16384
  v_mfma_f32_32x32x16_bf16 v[80:95], v[148:151], v[44:47], v[80:95]
  v_rcp_f32 v21, v21
  ds_read_b128 v[44:47], v4 offset:16384
  s_waitcnt lgkmcnt(3)
  v_mfma_f32_32x32x16_bf16 v[80:95], v[152:155], v[28:31], v[80:95]
  v_mul_f32 v64, v64, v20
  v_mul_f32 v65, v65, v21
  v_cvt_pk_bf16_f32 v72, v64, v65
  ds_read_b128 v[28:31], v5 offset:16384
  v_mfma_f32_32x32x16_bf16 v[80:95], v[156:159], v[32:35], v[80:95]
  v_mul_f32 v23, v16, v67
  v_mul_f32 v66, v66, v74
  ds_read_b128 v[32:35], v2 offset:20480
  s_waitcnt lgkmcnt(3)
  v_mfma_f32_32x32x16_bf16 v[80:95], v[160:163], v[36:39], v[80:95]
  v_exp_f32 v22, v22
  v_mul_f32 v67, v67, v75
  ds_read_b128 v[36:39], v3 offset:20480
  v_mfma_f32_32x32x16_bf16 v[80:95], v[164:167], v[40:43], v[80:95]
  v_exp_f32 v23, v23
  ds_read_b128 v[40:43], v4 offset:20480
  s_waitcnt lgkmcnt(3)
  v_mfma_f32_32x32x16_bf16 v[80:95], v[168:171], v[44:47], v[80:95]
  v_fma_f32 v22, v22, v17, v17
  v_fma_f32 v23, v23, v17, v17
  v_mul_f32 v20, v16, v68
  ds_read_b128 v[44:47], v5 offset:20480
  v_mfma_f32_32x32x16_bf16 v[80:95], v[172:175], v[28:31], v[80:95]
  v_rcp_f32 v22, v22
  ds_read_b128 v[28:31], v2 offset:24576
  s_waitcnt lgkmcnt(3)
  v_mfma_f32_32x32x16_bf16 v[80:95], v[176:179], v[32:35], v[80:95]
  v_rcp_f32 v23, v23
  v_mul_f32 v66, v66, v22
  ds_read_b128 v[32:35], v3 offset:24576
  v_mfma_f32_32x32x16_bf16 v[80:95], v[180:183], v[36:39], v[80:95]
  v_mul_f32 v67, v67, v23
  v_cvt_pk_bf16_f32 v73, v66, v67
  ds_read_b128 v[36:39], v4 offset:24576
  s_waitcnt lgkmcnt(3)
  v_mfma_f32_32x32x16_bf16 v[80:95], v[184:187], v[40:43], v[80:95]
  v_mul_f32 v21, v16, v69
  v_exp_f32 v20, v20
  ds_read_b128 v[40:43], v5 offset:24576
  v_mfma_f32_32x32x16_bf16 v[80:95], v[188:191], v[44:47], v[80:95]
  v_exp_f32 v21, v21
  ds_read_b128 v[44:47], v2 offset:28672
  s_waitcnt lgkmcnt(3)
  v_mfma_f32_32x32x16_bf16 v[80:95], v[192:195], v[28:31], v[80:95]
  v_fma_f32 v20, v20, v17, v17
  v_fma_f32 v21, v21, v17, v17
  v_mul_f32 v68, v68, v76
  ds_read_b128 v[28:31], v3 offset:28672
  v_mfma_f32_32x32x16_bf16 v[80:95], v[196:199], v[32:35], v[80:95]
  v_rcp_f32 v20, v20
  ds_read_b128 v[32:35], v4 offset:28672
  s_waitcnt lgkmcnt(3)
  v_mfma_f32_32x32x16_bf16 v[80:95], v[200:203], v[36:39], v[80:95]
  v_rcp_f32 v21, v21
  v_mul_f32 v69, v69, v77
  ds_read_b128 v[36:39], v5 offset:28672
  v_mfma_f32_32x32x16_bf16 v[80:95], v[204:207], v[40:43], v[80:95]
  v_mul_f32 v68, v68, v20
  v_mul_f32 v69, v69, v21
  ds_read_b128 v[40:43], v2 offset:32768
  s_waitcnt lgkmcnt(3)
  v_mfma_f32_32x32x16_bf16 v[80:95], v[208:211], v[44:47], v[80:95]
  v_cvt_pk_bf16_f32 v74, v68, v69
  v_mul_f32 v22, v16, v70
  v_mul_f32 v23, v16, v71
  ds_read_b128 v[44:47], v3 offset:32768
  v_mfma_f32_32x32x16_bf16 v[80:95], v[212:215], v[28:31], v[80:95]
  v_exp_f32 v22, v22
  ds_read_b128 v[28:31], v4 offset:32768
  s_waitcnt lgkmcnt(3)
  v_mfma_f32_32x32x16_bf16 v[80:95], v[216:219], v[32:35], v[80:95]
  v_exp_f32 v23, v23
  v_fma_f32 v22, v22, v17, v17
  ds_read_b128 v[32:35], v5 offset:32768
  v_mfma_f32_32x32x16_bf16 v[80:95], v[220:223], v[36:39], v[80:95]
  v_fma_f32 v23, v23, v17, v17
  v_mul_f32 v70, v70, v78
  ds_read_b128 v[36:39], v2 offset:36864
  s_waitcnt lgkmcnt(3)
  v_mfma_f32_32x32x16_bf16 v[80:95], v[224:227], v[40:43], v[80:95]
  s_waitcnt vmcnt(0)
  v_mov_b32 v1, 1
  s_mov_b64 exec, 1
  ds_add_rtn_u32 v1, v6, v1 offset:20
  s_mov_b64 exec, -1
  v_rcp_f32 v22, v22
  v_mul_f32 v71, v71, v79
  ds_read_b128 v[40:43], v3 offset:36864
  v_mfma_f32_32x32x16_bf16 v[80:95], v[228:231], v[44:47], v[80:95]
  v_rcp_f32 v23, v23
  ds_read_b128 v[44:47], v4 offset:36864
  s_waitcnt lgkmcnt(4)
  v_mfma_f32_32x32x16_bf16 v[80:95], v[232:235], v[28:31], v[80:95]
  v_mul_f32 v70, v70, v22
  v_mul_f32 v71, v71, v23
  v_cvt_pk_bf16_f32 v75, v70, v71
  ds_read_b128 v[28:31], v5 offset:36864
  v_mfma_f32_32x32x16_bf16 v[80:95], v[236:239], v[32:35], v[80:95]
  s_waitcnt lgkmcnt(3)
  v_readfirstlane_b32 s71, v1
  s_nop 1
  s_cmp_lg_u32 s71, s34
  s_cbranch_scc1 L_notlast_17
  s_add_u32 s77, s79, 0
  buffer_store_dwordx4 v[8:11], v9, s[36:39], s77 offen sc1
L_notlast_17:
  s_add_u32 s76, s78, 393216
  buffer_store_dwordx4 v[72:75], v7, s[36:39], s76 offen sc1
  s_barrier
  v_subrev_u32 v2, 81920, v2
  v_subrev_u32 v3, 81920, v3
  v_subrev_u32 v4, 81920, v4
  v_subrev_u32 v5, 81920, v5
  ds_read_b128 v[32:35], v2 offset:0
  s_waitcnt lgkmcnt(3)
  v_mfma_f32_32x32x16_bf16 v[80:95], v[240:243], v[36:39], v[80:95]
  ds_read_b128 v[36:39], v3 offset:0
  v_mfma_f32_32x32x16_bf16 v[80:95], v[244:247], v[40:43], v[80:95]
  ds_read_b128 v[40:43], v4 offset:0
  s_waitcnt lgkmcnt(3)
  v_mfma_f32_32x32x16_bf16 v[80:95], v[248:251], v[44:47], v[80:95]
  ds_read_b128 v[44:47], v5 offset:0
  v_mfma_f32_32x32x16_bf16 v[80:95], v[252:255], v[28:31], v[80:95]
  ds_read_b128 v[28:31], v2 offset:4096
  s_waitcnt lgkmcnt(3)
  v_mfma_f32_32x32x16_bf16 v[48:63], v[96:99], v[32:35], 0
  ds_read_b32 v10, v6 offset:2560
  ds_read_b128 v[32:35], v3 offset:4096
  v_mfma_f32_32x32x16_bf16 v[48:63], v[100:103], v[36:39], v[48:63]
  ds_read_b64 v[18:19], v6 offset:2568
  ds_read_b128 v[36:39], v4 offset:4096
  s_waitcnt lgkmcnt(5)
  v_mfma_f32_32x32x16_bf16 v[48:63], v[104:107], v[40:43], v[48:63]
  ds_read_b128 v[40:43], v5 offset:4096
  v_mfma_f32_32x32x16_bf16 v[48:63], v[108:111], v[44:47], v[48:63]
  ds_read_b128 v[44:47], v2 offset:8192
  s_waitcnt lgkmcnt(4)
  v_mfma_f32_32x32x16_bf16 v[48:63], v[112:115], v[28:31], v[48:63]
  ds_read_b128 v[28:31], v3 offset:8192
  v_mfma_f32_32x32x16_bf16 v[48:63], v[116:119], v[32:35], v[48:63]
  s_waitcnt lgkmcnt(4)
  v_mfma_f32_32x32x16_bf16 v[80:95], v[12:15], v[10:13], v[80:95]
  ds_read_b128 v[32:35], v4 offset:8192
  s_waitcnt lgkmcnt(3)
  v_mfma_f32_32x32x16_bf16 v[48:63], v[120:123], v[36:39], v[48:63]
  ds_read_b128 v[36:39], v5 offset:8192
  v_mfma_f32_32x32x16_bf16 v[48:63], v[124:127], v[40:43], v[48:63]
  ds_read_b128 v[40:43], v2 offset:12288
  s_waitcnt lgkmcnt(3)
  v_mfma_f32_32x32x16_bf16 v[48:63], v[128:131], v[44:47], v[48:63]
  s_nop 3
  v_mul_f32 v20, v18, v80
  v_mul_f32 v21, v18, v81
  v_mul_f32 v80, v80, v88
  ds_read_b128 v[44:47], v3 offset:12288
  v_mfma_f32_32x32x16_bf16 v[48:63], v[132:135], v[28:31], v[48:63]
  v_exp_f32 v20, v20
  ds_read_b128 v[28:31], v4 offset:12288
  s_waitcnt lgkmcnt(3)
  v_mfma_f32_32x32x16_bf16 v[48:63], v[136:139], v[32:35], v[48:63]
  v_exp_f32 v21, v21
  v_fma_f32 v20, v20, v19, v19
  ds_read_b128 v[32:35], v5 offset:12288
  v_mfma_f32_32x32x16_bf16 v[48:63], v[140:143], v[36:39], v[48:63]
  v_fma_f32 v21, v21, v19, v19
  v_mul_f32 v81, v81, v89
  ds_read_b128 v[36:39], v2 offset:16384
  s_waitcnt lgkmcnt(3)
  v_mfma_f32_32x32x16_bf16 v[48:63], v[144:147], v[40:43], v[48:63]
  v_rcp_f32 v20, v20
  v_mul_f32 v22, v18, v82
  ds_read_b128 v[40:43], v3 offset:16384
  v_mfma_f32_32x32x16_bf16 v[48:63], v[148:151], v[44:47], v[48:63]
  v_rcp_f32 v21, v21
  ds_read_b128 v[44:47], v4 offset:16384
  s_waitcnt lgkmcnt(3)
  v_mfma_f32_32x32x16_bf16 v[48:63], v[152:155], v[28:31], v[48:63]
  v_mul_f32 v80, v80, v20
  v_mul_f32 v81, v81, v21
  v_cvt_pk_bf16_f32 v88, v80, v81
  ds_read_b128 v[28:31], v5 offset:16384
  v_mfma_f32_32x32x16_bf16 v[48:63], v[156:159], v[32:35], v[48:63]
  v_mul_f32 v23, v18, v83
  v_mul_f32 v82, v82, v90
  ds_read_b128 v[32:35], v2 offset:20480
  s_waitcnt lgkmcnt(3)
  v_mfma_f32_32x32x16_bf16 v[48:63], v[160:163], v[36:39], v[48:63]
  v_exp_f32 v22, v22
  v_mul_f32 v83, v83, v91
  ds_read_b128 v[36:39], v3 offset:20480
  v_mfma_f32_32x32x16_bf16 v[48:63], v[164:167], v[40:43], v[48:63]
  v_exp_f32 v23, v23
  ds_read_b128 v[40:43], v4 offset:20480
  s_waitcnt lgkmcnt(3)
  v_mfma_f32_32x32x16_bf16 v[48:63], v[168:171], v[44:47], v[48:63]
  v_fma_f32 v22, v22, v19, v19
  v_fma_f32 v23, v23, v19, v19
  v_mul_f32 v20, v18, v84
  ds_read_b128 v[44:47], v5 offset:20480
  v_mfma_f32_32x32x16_bf16 v[48:63], v[172:175], v[28:31], v[48:63]
  v_rcp_f32 v22, v22
  ds_read_b128 v[28:31], v2 offset:24576
  s_waitcnt lgkmcnt(3)
  v_mfma_f32_32x32x16_bf16 v[48:63], v[176:179], v[32:35], v[48:63]
  v_rcp_f32 v23, v23
  v_mul_f32 v82, v82, v22
  ds_read_b128 v[32:35], v3 offset:24576
  v_mfma_f32_32x32x16_bf16 v[48:63], v[180:183], v[36:39], v[48:63]
  v_mul_f32 v83, v83, v23
  v_cvt_pk_bf16_f32 v89, v82, v83
  ds_read_b128 v[36:39], v4 offset:24576
  s_waitcnt lgkmcnt(3)
  v_mfma_f32_32x32x16_bf16 v[48:63], v[184:187], v[40:43], v[48:63]
  v_mul_f32 v21, v18, v85
  v_exp_f32 v20, v20
  ds_read_b128 v[40:43], v5 offset:24576
  v_mfma_f32_32x32x16_bf16 v[48:63], v[188:191], v[44:47], v[48:63]
  v_exp_f32 v21, v21
  ds_read_b128 v[44:47], v2 offset:28672
  s_waitcnt lgkmcnt(3)
  v_mfma_f32_32x32x16_bf16 v[48:63], v[192:195], v[28:31], v[48:63]
  v_fma_f32 v20, v20, v19, v19
  v_fma_f32 v21, v21, v19, v19
  v_mul_f32 v84, v84, v92
  ds_read_b128 v[28:31], v3 offset:28672
  v_mfma_f32_32x32x16_bf16 v[48:63], v[196:199], v[32:35], v[48:63]
  v_rcp_f32 v20, v20
  ds_read_b128 v[32:35], v4 offset:28672
  s_waitcnt lgkmcnt(3)
  v_mfma_f32_32x32x16_bf16 v[48:63], v[200:203], v[36:39], v[48:63]
  v_rcp_f32 v21, v21
  v_mul_f32 v85, v85, v93
  ds_read_b128 v[36:39], v5 offset:28672
  v_mfma_f32_32x32x16_bf16 v[48:63], v[204:207], v[40:43], v[48:63]
  v_mul_f32 v84, v84, v20
  v_mul_f32 v85, v85, v21
  ds_read_b128 v[40:43], v2 offset:32768
  s_waitcnt lgkmcnt(3)
  v_mfma_f32_32x32x16_bf16 v[48:63], v[208:211], v[44:47], v[48:63]
  v_cvt_pk_bf16_f32 v90, v84, v85
  v_mul_f32 v22, v18, v86
  v_mul_f32 v23, v18, v87
  ds_read_b128 v[44:47], v3 offset:32768
  v_mfma_f32_32x32x16_bf16 v[48:63], v[212:215], v[28:31], v[48:63]
  v_exp_f32 v22, v22
  ds_read_b128 v[28:31], v4 offset:32768
  s_waitcnt lgkmcnt(3)
  v_mfma_f32_32x32x16_bf16 v[48:63], v[216:219], v[32:35], v[48:63]
  v_exp_f32 v23, v23
  v_fma_f32 v22, v22, v19, v19
  ds_read_b128 v[32:35], v5 offset:32768
  v_mfma_f32_32x32x16_bf16 v[48:63], v[220:223], v[36:39], v[48:63]
  v_fma_f32 v23, v23, v19, v19
  v_mul_f32 v86, v86, v94
  ds_read_b128 v[36:39], v2 offset:36864
  s_waitcnt lgkmcnt(3)
  v_mfma_f32_32x32x16_bf16 v[48:63], v[224:227], v[40:43], v[48:63]
  v_rcp_f32 v22, v22
  v_mul_f32 v87, v87, v95
  ds_read_b128 v[40:43], v3 offset:36864
  v_mfma_f32_32x32x16_bf16 v[48:63], v[228:231], v[44:47], v[48:63]
  v_rcp_f32 v23, v23
  ds_read_b128 v[44:47], v4 offset:36864
  s_waitcnt lgkmcnt(3)
  v_mfma_f32_32x32x16_bf16 v[48:63], v[232:235], v[28:31], v[48:63]
  v_mul_f32 v86, v86, v22
  v_mul_f32 v87, v87, v23
  v_cvt_pk_bf16_f32 v91, v86, v87
  ds_read_b128 v[28:31], v5 offset:36864
  v_mfma_f32_32x32x16_bf16 v[48:63], v[236:239], v[32:35], v[48:63]
  s_add_u32 s76, s78, 491520
  buffer_store_dwordx4 v[88:91], v7, s[36:39], s76 offen sc1
  s_waitcnt lgkmcnt(0)
  s_barrier
  v_add_u32 v2, 40960, v2
  v_add_u32 v3, 40960, v3
  v_add_u32 v4, 40960, v4
  v_add_u32 v5, 40960, v5
  ds_read_b128 v[32:35], v2 offset:0
  v_mfma_f32_32x32x16_bf16 v[48:63], v[240:243], v[36:39], v[48:63]
  ds_read_b128 v[36:39], v3 offset:0
  v_mfma_f32_32x32x16_bf16 v[48:63], v[244:247], v[40:43], v[48:63]
  ds_read_b128 v[40:43], v4 offset:0
  v_mfma_f32_32x32x16_bf16 v[48:63], v[248:251], v[44:47], v[48:63]
  ds_read_b128 v[44:47], v5 offset:0
  v_mfma_f32_32x32x16_bf16 v[48:63], v[252:255], v[28:31], v[48:63]
  ds_read_b128 v[28:31], v2 offset:4096
  s_waitcnt lgkmcnt(3)
  v_mfma_f32_32x32x16_bf16 v[64:79], v[96:99], v[32:35], 0
  ds_read_b32 v10, v6 offset:3072
  ds_read_b128 v[32:35], v3 offset:4096
  v_mfma_f32_32x32x16_bf16 v[64:79], v[100:103], v[36:39], v[64:79]
  ds_read_b64 v[16:17], v6 offset:3080
  ds_read_b128 v[36:39], v4 offset:4096
  s_waitcnt lgkmcnt(5)
  v_mfma_f32_32x32x16_bf16 v[64:79], v[104:107], v[40:43], v[64:79]
  ds_read_b128 v[40:43], v5 offset:4096
  v_mfma_f32_32x32x16_bf16 v[64:79], v[108:111], v[44:47], v[64:79]
  ds_read_b128 v[44:47], v2 offset:8192
  s_waitcnt lgkmcnt(4)
  v_mfma_f32_32x32x16_bf16 v[64:79], v[112:115], v[28:31], v[64:79]
  ds_read_b128 v[28:31], v3 offset:8192
  v_mfma_f32_32x32x16_bf16 v[64:79], v[116:119], v[32:35], v[64:79]
  s_waitcnt lgkmcnt(4)
  v_mfma_f32_32x32x16_bf16 v[48:63], v[12:15], v[10:13], v[48:63]
  ds_read_b128 v[32:35], v4 offset:8192
  s_waitcnt lgkmcnt(3)
  v_mfma_f32_32x32x16_bf16 v[64:79], v[120:123], v[36:39], v[64:79]
  ds_read_b128 v[36:39], v5 offset:8192
  v_mfma_f32_32x32x16_bf16 v[64:79], v[124:127], v[40:43], v[64:79]
  ds_read_b128 v[40:43], v2 offset:12288
  s_waitcnt lgkmcnt(3)
  v_mfma_f32_32x32x16_bf16 v[64:79], v[128:131], v[44:47], v[64:79]
  s_nop 3
  v_mul_f32 v20, v16, v48
  v_mul_f32 v21, v16, v49
  v_mul_f32 v48, v48, v56
  ds_read_b128 v[44:47], v3 offset:12288
  v_mfma_f32_32x32x16_bf16 v[64:79], v[132:135], v[28:31], v[64:79]
  v_exp_f32 v20, v20
  ds_read_b128 v[28:31], v4 offset:12288
  s_waitcnt lgkmcnt(3)
  v_mfma_f32_32x32x16_bf16 v[64:79], v[136:139], v[32:35], v[64:79]
  v_exp_f32 v21, v21
  v_fma_f32 v20, v20, v17, v17
  ds_read_b128 v[32:35], v5 offset:12288
  v_mfma_f32_32x32x16_bf16 v[64:79], v[140:143], v[36:39], v[64:79]
  v_fma_f32 v21, v21, v17, v17
  v_mul_f32 v49, v49, v57
  ds_read_b128 v[36:39], v2 offset:16384
  s_waitcnt lgkmcnt(3)
  v_mfma_f32_32x32x16_bf16 v[64:79], v[144:147], v[40:43], v[64:79]
  v_rcp_f32 v20, v20
  v_mul_f32 v22, v16, v50
  ds_read_b128 v[40:43], v3 offset:16384
  v_mfma_f32_32x32x16_bf16 v[64:79], v[148:151], v[44:47], v[64:79]
  v_rcp_f32 v21, v21
  ds_read_b128 v[44:47], v4 offset:16384
  s_waitcnt lgkmcnt(3)
  v_mfma_f32_32x32x16_bf16 v[64:79], v[152:155], v[28:31], v[64:79]
  v_mul_f32 v48, v48, v20
  v_mul_f32 v49, v49, v21
  v_cvt_pk_bf16_f32 v56, v48, v49
  ds_read_b128 v[28:31], v5 offset:16384
  v_mfma_f32_32x32x16_bf16 v[64:79], v[156:159], v[32:35], v[64:79]
  v_mul_f32 v23, v16, v51
  v_mul_f32 v50, v50, v58
  ds_read_b128 v[32:35], v2 offset:20480
  s_waitcnt lgkmcnt(3)
  v_mfma_f32_32x32x16_bf16 v[64:79], v[160:163], v[36:39], v[64:79]
  v_exp_f32 v22, v22
  v_mul_f32 v51, v51, v59
  ds_read_b128 v[36:39], v3 offset:20480
  v_mfma_f32_32x32x16_bf16 v[64:79], v[164:167], v[40:43], v[64:79]
  v_exp_f32 v23, v23
  ds_read_b128 v[40:43], v4 offset:20480
  s_waitcnt lgkmcnt(3)
  v_mfma_f32_32x32x16_bf16 v[64:79], v[168:171], v[44:47], v[64:79]
  v_fma_f32 v22, v22, v17, v17
  v_fma_f32 v23, v23, v17, v17
  v_mul_f32 v20, v16, v52
  ds_read_b128 v[44:47], v5 offset:20480
  v_mfma_f32_32x32x16_bf16 v[64:79], v[172:175], v[28:31], v[64:79]
  v_rcp_f32 v22, v22
  ds_read_b128 v[28:31], v2 offset:24576
  s_waitcnt lgkmcnt(3)
  v_mfma_f32_32x32x16_bf16 v[64:79], v[176:179], v[32:35], v[64:79]
  v_rcp_f32 v23, v23
  v_mul_f32 v50, v50, v22
  ds_read_b128 v[32:35], v3 offset:24576
  v_mfma_f32_32x32x16_bf16 v[64:79], v[180:183], v[36:39], v[64:79]
  v_mul_f32 v51, v51, v23
  v_cvt_pk_bf16_f32 v57, v50, v51
  ds_read_b128 v[36:39], v4 offset:24576
  s_waitcnt lgkmcnt(3)
  v_mfma_f32_32x32x16_bf16 v[64:79], v[184:187], v[40:43], v[64:79]
  v_mul_f32 v21, v16, v53
  v_exp_f32 v20, v20
  ds_read_b128 v[40:43], v5 offset:24576
  v_mfma_f32_32x32x16_bf16 v[64:79], v[188:191], v[44:47], v[64:79]
  v_exp_f32 v21, v21
  ds_read_b128 v[44:47], v2 offset:28672
  s_waitcnt lgkmcnt(3)
  v_mfma_f32_32x32x16_bf16 v[64:79], v[192:195], v[28:31], v[64:79]
  v_fma_f32 v20, v20, v17, v17
  v_fma_f32 v21, v21, v17, v17
  v_mul_f32 v52, v52, v60
  ds_read_b128 v[28:31], v3 offset:28672
  v_mfma_f32_32x32x16_bf16 v[64:79], v[196:199], v[32:35], v[64:79]
  v_rcp_f32 v20, v20
  ds_read_b128 v[32:35], v4 offset:28672
  s_waitcnt lgkmcnt(3)
  v_mfma_f32_32x32x16_bf16 v[64:79], v[200:203], v[36:39], v[64:79]
  v_rcp_f32 v21, v21
  v_mul_f32 v53, v53, v61
  ds_read_b128 v[36:39], v5 offset:28672
  v_mfma_f32_32x32x16_bf16 v[64:79], v[204:207], v[40:43], v[64:79]
  v_mul_f32 v52, v52, v20
  v_mul_f32 v53, v53, v21
  ds_read_b128 v[40:43], v2 offset:32768
  s_waitcnt lgkmcnt(3)
  v_mfma_f32_32x32x16_bf16 v[64:79], v[208:211], v[44:47], v[64:79]
  v_cvt_pk_bf16_f32 v58, v52, v53
  v_mul_f32 v22, v16, v54
  v_mul_f32 v23, v16, v55
  ds_read_b128 v[44:47], v3 offset:32768
  v_mfma_f32_32x32x16_bf16 v[64:79], v[212:215], v[28:31], v[64:79]
  v_exp_f32 v22, v22
  ds_read_b128 v[28:31], v4 offset:32768
  s_waitcnt lgkmcnt(3)
  v_mfma_f32_32x32x16_bf16 v[64:79], v[216:219], v[32:35], v[64:79]
  v_exp_f32 v23, v23
  v_fma_f32 v22, v22, v17, v17
  ds_read_b128 v[32:35], v5 offset:32768
  v_mfma_f32_32x32x16_bf16 v[64:79], v[220:223], v[36:39], v[64:79]
  v_fma_f32 v23, v23, v17, v17
  v_mul_f32 v54, v54, v62
  ds_read_b128 v[36:39], v2 offset:36864
  s_waitcnt lgkmcnt(3)
  v_mfma_f32_32x32x16_bf16 v[64:79], v[224:227], v[40:43], v[64:79]
  v_rcp_f32 v22, v22
  v_mul_f32 v55, v55, v63
  ds_read_b128 v[40:43], v3 offset:36864
  v_mfma_f32_32x32x16_bf16 v[64:79], v[228:231], v[44:47], v[64:79]
  v_rcp_f32 v23, v23
  ds_read_b128 v[44:47], v4 offset:36864
  s_waitcnt lgkmcnt(3)
  v_mfma_f32_32x32x16_bf16 v[64:79], v[232:235], v[28:31], v[64:79]
  v_mul_f32 v54, v54, v22
  v_mul_f32 v55, v55, v23
  v_cvt_pk_bf16_f32 v59, v54, v55
  ds_read_b128 v[28:31], v5 offset:36864
  v_mfma_f32_32x32x16_bf16 v[64:79], v[236:239], v[32:35], v[64:79]
  s_waitcnt lgkmcnt(2)
  v_mfma_f32_32x32x16_bf16 v[64:79], v[240:243], v[36:39], v[64:79]
  v_mfma_f32_32x32x16_bf16 v[64:79], v[244:247], v[40:43], v[64:79]
  s_waitcnt lgkmcnt(0)
  v_mfma_f32_32x32x16_bf16 v[64:79], v[248:251], v[44:47], v[64:79]
  v_mfma_f32_32x32x16_bf16 v[64:79], v[252:255], v[28:31], v[64:79]
  ds_read_b32 v10, v6 offset:3584
  ds_read_b64 v[18:19], v6 offset:3592
  s_waitcnt vmcnt(0)
  v_mov_b32 v1, 1
  s_mov_b64 exec, 1
  ds_add_rtn_u32 v1, v6, v1 offset:36
  s_mov_b64 exec, -1
  s_waitcnt lgkmcnt(1)
  v_mfma_f32_32x32x16_bf16 v[64:79], v[12:15], v[10:13], v[64:79]
  s_add_u32 s76, s78, 589824
  buffer_store_dwordx4 v[56:59], v7, s[36:39], s76 offen sc1
  s_waitcnt lgkmcnt(0)
  v_readfirstlane_b32 s71, v1
  s_nop 1
  s_cmp_lg_u32 s71, s34
  s_cbranch_scc1 L_notlast_18
  s_add_u32 s77, s79, 3072
  buffer_store_dwordx4 v[8:11], v9, s[36:39], s77 offen sc1
L_notlast_18:
  s_nop 1
  s_nop 1
  v_mul_f32 v20, v18, v64
  v_mul_f32 v21, v18, v65
  v_exp_f32 v20, v20
  v_exp_f32 v21, v21
  v_fma_f32 v20, v20, v19, v19
  v_fma_f32 v21, v21, v19, v19
  v_rcp_f32 v20, v20
  v_rcp_f32 v21, v21
  v_mul_f32 v64, v64, v72
  v_mul_f32 v65, v65, v73
  v_mul_f32 v64, v64, v20
  v_mul_f32 v65, v65, v21
  v_cvt_pk_bf16_f32 v72, v64, v65
  v_mul_f32 v22, v18, v66
  v_mul_f32 v23, v18, v67
  v_exp_f32 v22, v22
  v_exp_f32 v23, v23
  v_fma_f32 v22, v22, v19, v19
  v_fma_f32 v23, v23, v19, v19
  v_rcp_f32 v22, v22
  v_rcp_f32 v23, v23
  v_mul_f32 v66, v66, v74
  v_mul_f32 v67, v67, v75
  v_mul_f32 v66, v66, v22
  v_mul_f32 v67, v67, v23
  v_cvt_pk_bf16_f32 v73, v66, v67
  v_mul_f32 v20, v18, v68
  v_mul_f32 v21, v18, v69
  v_exp_f32 v20, v20
  v_exp_f32 v21, v21
  v_fma_f32 v20, v20, v19, v19
  v_fma_f32 v21, v21, v19, v19
  v_rcp_f32 v20, v20
  v_rcp_f32 v21, v21
  v_mul_f32 v68, v68, v76
  v_mul_f32 v69, v69, v77
  v_mul_f32 v68, v68, v20
  v_mul_f32 v69, v69, v21
  v_cvt_pk_bf16_f32 v74, v68, v69
  v_mul_f32 v22, v18, v70
  v_mul_f32 v23, v18, v71
  v_exp_f32 v22, v22
  v_exp_f32 v23, v23
  v_fma_f32 v22, v22, v19, v19
  v_fma_f32 v23, v23, v19, v19
  v_rcp_f32 v22, v22
  v_rcp_f32 v23, v23
  v_mul_f32 v70, v70, v78
  v_mul_f32 v71, v71, v79
  v_mul_f32 v70, v70, v22
  v_mul_f32 v71, v71, v23
  v_cvt_pk_bf16_f32 v75, v70, v71
  s_add_u32 s76, s78, 688128
  buffer_store_dwordx4 v[72:75], v7, s[36:39], s76 offen sc1
  s_setprio 0
  s_add_u32 s35, s79, 6144
  v_mov_b32 v26, 155648
  s_cmp_lt_u32 s66, 5
  s_cbranch_scc1 L_reduce
  s_waitcnt vmcnt(0)
  v_mov_b32 v27, 1
  s_mov_b64 exec, 1
  ds_add_rtn_u32 v27, v26, v27 offset:52
  s_mov_b64 exec, -1
  s_waitcnt lgkmcnt(0)
  v_readfirstlane_b32 s71, v27
  s_nop 1
  s_cmp_lg_u32 s71, s34
  s_cbranch_scc1 L_notlast_19
  buffer_store_dwordx4 v[8:11], v9, s[36:39], s35 offen sc1
L_notlast_19:
  s_cmp_lg_u32 s2, 160
  s_cbranch_scc1 L_fin
  s_cmp_lg_u32 s60, 0
  s_cbranch_scc1 L_fin
  v_lshlrev_b32 v7, 7, v0
  s_mov_b32 s71, 0
L_poll_20:
  s_mov_b32 s76, 81920
  buffer_load_dword v20, v7, s[36:39], s76 offen sc1
  s_mov_b32 s76, 90112
  buffer_load_dword v21, v7, s[36:39], s76 offen sc1
  s_mov_b32 s76, 98304
  buffer_load_dword v22, v7, s[36:39], s76 offen sc1
  s_mov_b32 s76, 106496
  buffer_load_dword v23, v7, s[36:39], s76 offen sc1
  s_mov_b32 s76, 114688
  buffer_load_dword v24, v7, s[36:39], s76 offen sc1
  s_add_u32 s71, s71, 1
  s_cmp_ge_u32 s71, 200000
  s_waitcnt vmcnt(0)
  s_cbranch_scc1 L_ready_22
L_chk_21:
  v_xor_b32 v20, s63, v20
  v_xor_b32 v21, s63, v21
  v_xor_b32 v22, s63, v22
  v_xor_b32 v23, s63, v23
  v_xor_b32 v24, s63, v24
  v_or3_b32 v20, v20, v21, v22
  v_or3_b32 v20, v20, v23, v24
  v_cmp_ne_u32 vcc, 0, v20
  s_nop 1
  s_cbranch_vccnz L_poll_20
L_ready_22:
  buffer_store_dwordx4 v[8:11], v9, s[36:39], 0 offen sc1
  s_branch L_fin
L_reduce:
  s_mov_b32 s40, s8
  s_mov_b32 s41, s9
  s_mov_b32 s42, 2621440
  s_mov_b32 s43, 0x20000
  s_mov_b32 s44, s28
  s_mov_b32 s45, s29
  s_mov_b32 s46, 2621440
  s_mov_b32 s47, 0x20000
  s_lshl_b32 s76, s60, 7
  v_bfe_u32 v1, v0, 2, 3
  v_mul_u32_u24 v1, 576, v1
  v_and_b32 v24, 3, v0
  v_lshlrev_b32 v24, 4, v24
  v_add_u32 v1, v1, v24
  v_bfe_u32 v24, v0, 5, 1
  v_lshlrev_b32 v24, 6, v24
  v_add_u32 v1, v1, v24
  v_add_u32 v1, s76, v1
  s_lshl_b32 s76, s64, 3
  s_add_u32 s76, s76, s67
  s_lshl_b32 s76, s76, 2
  s_add_u32 s76, s76, s60
  s_mul_i32 s76, s76, 10240
  s_lshl_b32 s77, s68, 7
  s_add_u32 s76, s76, s77
  v_bfe_u32 v2, v0, 3, 3
  v_mul_u32_u24 v2, 1280, v2
  v_and_b32 v24, 7, v0
  v_lshlrev_b32 v24, 4, v24
  v_add_u32 v2, v2, v24
  v_add_u32 v2, s76, v2
  s_mul_i32 s77, s60, 5120
  v_and_b32 v7, 3, v0
  v_mul_u32_u24 v7, 160, v7
  v_bfe_u32 v24, v0, 5, 1
  v_mul_u32_u24 v24, 640, v24
  v_add_u32 v7, v7, v24
  v_bfe_u32 v24, v0, 2, 3
  v_lshlrev_b32 v24, 4, v24
  v_add_u32 v7, v7, v24
  v_add_u32 v7, s77, v7
  v_bfe_u32 v10, v0, 3, 3
  v_mul_u32_u24 v10, 160, v10
  v_and_b32 v24, 7, v0
  v_lshlrev_b32 v24, 4, v24
  v_add_u32 v10, v10, v24
  v_add_u32 v10, s77, v10
  s_mov_b32 s77, 114688
  s_cmp_eq_u32 s60, 1
  s_cselect_b32 s77, 118784, s77
  s_cmp_eq_u32 s60, 2
  s_cselect_b32 s77, 159744, s77
  s_cmp_eq_u32 s60, 3
  s_cselect_b32 s77, 36864, s77
  s_add_u32 m0, s77, 0
  s_mov_b32 s78, 0
  buffer_load_dwordx4 v2, s[40:43], s78 offen  lds
  s_add_u32 m0, s77, 1024
  s_mov_b32 s78, 81920
  buffer_load_dwordx4 v2, s[40:43], s78 offen  lds
  s_add_u32 m0, s77, 2048
  s_mov_b32 s78, 163840
  buffer_load_dwordx4 v2, s[40:43], s78 offen  lds
  s_add_u32 m0, s77, 3072
  s_mov_b32 s78, 245760
  buffer_load_dwordx4 v2, s[40:43], s78 offen  lds
  v_and_b32 v3, 3, v0
  v_lshlrev_b32 v3, 7, v3
  v_bfe_u32 v24, v0, 5, 1
  v_lshlrev_b32 v24, 9, v24
  v_add_u32 v3, v3, v24
  v_bfe_u32 v24, v0, 2, 3
  v_lshlrev_b32 v24, 4, v24
  v_add_u32 v3, v3, v24
  v_add_u32 v3, s77, v3
  s_lshl_b32 s76, s67, 9
  s_lshl_b32 s78, s60, 7
  s_add_u32 s76, s76, s78
  v_and_b32 v6, 3, v0
  v_lshlrev_b32 v6, 4, v6
  v_bfe_u32 v24, v0, 5, 1
  v_lshlrev_b32 v24, 6, v24
  v_add_u32 v6, v6, v24
  v_add_u32 v6, s76, v6
  v_add_u32 v6, 155648, v6
  v_bfe_u32 v22, v0, 4, 1
  v_lshlrev_b32 v22, 13, v22
  v_and_b32 v24, 3, v0
  v_lshlrev_b32 v24, 11, v24
  v_add_u32 v22, v22, v24
  v_bfe_u32 v24, v0, 2, 2
  v_lshlrev_b32 v24, 8, v24
  v_add_u32 v22, v22, v24
  v_bfe_u32 v24, v0, 5, 1
  v_lshlrev_b32 v24, 3, v24
  v_add_u32 v22, v22, v24
  v_add_u32 v22, 122880, v22
  v_bfe_u32 v23, v0, 2, 2
  v_xor_b32 v23, s60, v23
  v_lshl_add_u32 v22, v23, 4, v22
  v_and_b32 v23, 3, v0
  v_xor_b32 v24, 0, v23
  v_lshl_add_u32 v32, v24, 6, v22
  v_xor_b32 v24, 1, v23
  v_lshl_add_u32 v33, v24, 6, v22
  v_xor_b32 v24, 2, v23
  v_lshl_add_u32 v34, v24, 6, v22
  v_xor_b32 v24, 3, v23
  v_lshl_add_u32 v35, v24, 6, v22
  s_waitcnt vmcnt(0)
  v_mov_b32 v27, 1
  s_mov_b64 exec, 1
  ds_add_rtn_u32 v27, v26, v27 offset:52
  s_mov_b64 exec, -1
  s_waitcnt lgkmcnt(0)
  v_readfirstlane_b32 s71, v27
  s_nop 1
  s_cmp_lg_u32 s71, s34
  s_cbranch_scc1 L_notlast_23
  buffer_store_dwordx4 v[8:11], v9, s[36:39], s35 offen sc1
L_notlast_23:
  ds_read_b128 v[224:227], v6 offset:0
  ds_read_b128 v[228:231], v6 offset:1024
  ds_read_b128 v[232:235], v6 offset:2048
  ds_read_b128 v[236:239], v6 offset:3072
  ds_read_b128 v[192:195], v3 offset:0
  ds_read_b128 v[196:199], v3 offset:1024
  ds_read_b128 v[200:203], v3 offset:2048
  ds_read_b128 v[204:207], v3 offset:3072
  s_waitcnt lgkmcnt(3)
  v_lshlrev_b32 v96, 16, v192
  v_and_b32 v97, 0xffff0000, v192
  v_lshlrev_b32 v98, 16, v193
  v_and_b32 v99, 0xffff0000, v193
  v_lshlrev_b32 v100, 16, v194
  v_and_b32 v101, 0xffff0000, v194
  v_lshlrev_b32 v102, 16, v195
  v_and_b32 v103, 0xffff0000, v195
  v_and_b32 v224, 0xffff0000, v224
  v_rsq_f32 v225, v227
  v_add_f32 v128, v224, v96
  v_add_f32 v129, v224, v97
  v_add_f32 v130, v224, v98
  v_add_f32 v131, v224, v99
  v_add_f32 v132, v224, v100
  v_add_f32 v133, v224, v101
  v_add_f32 v134, v224, v102
  v_add_f32 v135, v224, v103
  v_mul_f32 v128, v225, v128
  v_mul_f32 v129, v225, v129
  v_mul_f32 v130, v225, v130
  v_mul_f32 v131, v225, v131
  v_mul_f32 v132, v225, v132
  v_mul_f32 v133, v225, v133
  v_mul_f32 v134, v225, v134
  v_mul_f32 v135, v225, v135
  s_waitcnt lgkmcnt(2)
  v_lshlrev_b32 v104, 16, v196
  v_and_b32 v105, 0xffff0000, v196
  v_lshlrev_b32 v106, 16, v197
  v_and_b32 v107, 0xffff0000, v197
  v_lshlrev_b32 v108, 16, v198
  v_and_b32 v109, 0xffff0000, v198
  v_lshlrev_b32 v110, 16, v199
  v_and_b32 v111, 0xffff0000, v199
  v_and_b32 v228, 0xffff0000, v228
  v_rsq_f32 v229, v231
  v_add_f32 v136, v228, v104
  v_add_f32 v137, v228, v105
  v_add_f32 v138, v228, v106
  v_add_f32 v139, v228, v107
  v_add_f32 v140, v228, v108
  v_add_f32 v141, v228, v109
  v_add_f32 v142, v228, v110
  v_add_f32 v143, v228, v111
  v_mul_f32 v136, v229, v136
  v_mul_f32 v137, v229, v137
  v_mul_f32 v138, v229, v138
  v_mul_f32 v139, v229, v139
  v_mul_f32 v140, v229, v140
  v_mul_f32 v141, v229, v141
  v_mul_f32 v142, v229, v142
  v_mul_f32 v143, v229, v143
  s_waitcnt lgkmcnt(1)
  v_lshlrev_b32 v112, 16, v200
  v_and_b32 v113, 0xffff0000, v200
  v_lshlrev_b32 v114, 16, v201
  v_and_b32 v115, 0xffff0000, v201
  v_lshlrev_b32 v116, 16, v202
  v_and_b32 v117, 0xffff0000, v202
  v_lshlrev_b32 v118, 16, v203
  v_and_b32 v119, 0xffff0000, v203
  v_and_b32 v232, 0xffff0000, v232
  v_rsq_f32 v233, v235
  v_add_f32 v144, v232, v112
  v_add_f32 v145, v232, v113
  v_add_f32 v146, v232, v114
  v_add_f32 v147, v232, v115
  v_add_f32 v148, v232, v116
  v_add_f32 v149, v232, v117
  v_add_f32 v150, v232, v118
  v_add_f32 v151, v232, v119
  v_mul_f32 v144, v233, v144
  v_mul_f32 v145, v233, v145
  v_mul_f32 v146, v233, v146
  v_mul_f32 v147, v233, v147
  v_mul_f32 v148, v233, v148
  v_mul_f32 v149, v233, v149
  v_mul_f32 v150, v233, v150
  v_mul_f32 v151, v233, v151
  s_waitcnt lgkmcnt(0)
  v_lshlrev_b32 v120, 16, v204
  v_and_b32 v121, 0xffff0000, v204
  v_lshlrev_b32 v122, 16, v205
  v_and_b32 v123, 0xffff0000, v205
  v_lshlrev_b32 v124, 16, v206
  v_and_b32 v125, 0xffff0000, v206
  v_lshlrev_b32 v126, 16, v207
  v_and_b32 v127, 0xffff0000, v207
  v_and_b32 v236, 0xffff0000, v236
  v_rsq_f32 v237, v239
  v_add_f32 v152, v236, v120
  v_add_f32 v153, v236, v121
  v_add_f32 v154, v236, v122
  v_add_f32 v155, v236, v123
  v_add_f32 v156, v236, v124
  v_add_f32 v157, v236, v125
  v_add_f32 v158, v236, v126
  v_add_f32 v159, v236, v127
  v_mul_f32 v152, v237, v152
  v_mul_f32 v153, v237, v153
  v_mul_f32 v154, v237, v154
  v_mul_f32 v155, v237, v155
  v_mul_f32 v156, v237, v156
  v_mul_f32 v157, v237, v157
  v_mul_f32 v158, v237, v158
  v_mul_f32 v159, v237, v159
  s_barrier
  ds_read_b128 v[160:163], v1 offset:0
  ds_read_b128 v[164:167], v1 offset:4608
  ds_read_b128 v[168:171], v1 offset:9216
  ds_read_b128 v[172:175], v1 offset:13824
  ds_read_b128 v[176:179], v1 offset:18432
  ds_read_b128 v[180:183], v1 offset:23040
  ds_read_b128 v[184:187], v1 offset:27648
  ds_read_b128 v[188:191], v1 offset:32256
  s_waitcnt lgkmcnt(6)
  v_add_f32 v96, v96, v160
  v_add_f32 v97, v97, v161
  v_add_f32 v98, v98, v162
  v_add_f32 v99, v99, v163
  v_add_f32 v100, v100, v164
  v_add_f32 v101, v101, v165
  v_add_f32 v102, v102, v166
  v_add_f32 v103, v103, v167
  s_waitcnt lgkmcnt(4)
  v_add_f32 v96, v96, v168
  v_add_f32 v97, v97, v169
  v_add_f32 v98, v98, v170
  v_add_f32 v99, v99, v171
  v_add_f32 v100, v100, v172
  v_add_f32 v101, v101, v173
  v_add_f32 v102, v102, v174
  v_add_f32 v103, v103, v175
  s_waitcnt lgkmcnt(2)
  v_add_f32 v96, v96, v176
  v_add_f32 v97, v97, v177
  v_add_f32 v98, v98, v178
  v_add_f32 v99, v99, v179
  v_add_f32 v100, v100, v180
  v_add_f32 v101, v101, v181
  v_add_f32 v102, v102, v182
  v_add_f32 v103, v103, v183
  s_waitcnt lgkmcnt(0)
  v_add_f32 v96, v96, v184
  v_add_f32 v97, v97, v185
  v_add_f32 v98, v98, v186
  v_add_f32 v99, v99, v187
  v_add_f32 v100, v100, v188
  v_add_f32 v101, v101, v189
  v_add_f32 v102, v102, v190
  v_add_f32 v103, v103, v191
  s_barrier
  v_add_u32 v1, 36864, v1
  ds_read_b128 v[160:163], v1 offset:0
  ds_read_b128 v[164:167], v1 offset:4608
  ds_read_b128 v[168:171], v1 offset:9216
  ds_read_b128 v[172:175], v1 offset:13824
  ds_read_b128 v[176:179], v1 offset:18432
  ds_read_b128 v[180:183], v1 offset:23040
  ds_read_b128 v[184:187], v1 offset:27648
  ds_read_b128 v[188:191], v1 offset:32256
  s_waitcnt lgkmcnt(6)
  v_add_f32 v104, v104, v160
  v_add_f32 v105, v105, v161
  v_add_f32 v106, v106, v162
  v_add_f32 v107, v107, v163
  v_add_f32 v108, v108, v164
  v_add_f32 v109, v109, v165
  v_add_f32 v110, v110, v166
  v_add_f32 v111, v111, v167
  s_waitcnt lgkmcnt(4)
  v_add_f32 v104, v104, v168
  v_add_f32 v105, v105, v169
  v_add_f32 v106, v106, v170
  v_add_f32 v107, v107, v171
  v_add_f32 v108, v108, v172
  v_add_f32 v109, v109, v173
  v_add_f32 v110, v110, v174
  v_add_f32 v111, v111, v175
  s_waitcnt lgkmcnt(2)
  v_add_f32 v104, v104, v176
  v_add_f32 v105, v105, v177
  v_add_f32 v106, v106, v178
  v_add_f32 v107, v107, v179
  v_add_f32 v108, v108, v180
  v_add_f32 v109, v109, v181
  v_add_f32 v110, v110, v182
  v_add_f32 v111, v111, v183
  s_waitcnt lgkmcnt(0)
  v_add_f32 v104, v104, v184
  v_add_f32 v105, v105, v185
  v_add_f32 v106, v106, v186
  v_add_f32 v107, v107, v187
  v_add_f32 v108, v108, v188
  v_add_f32 v109, v109, v189
  v_add_f32 v110, v110, v190
  v_add_f32 v111, v111, v191
  s_barrier
  v_subrev_u32 v1, 36864, v1
  ds_read_b128 v[160:163], v1 offset:0
  ds_read_b128 v[164:167], v1 offset:4608
  ds_read_b128 v[168:171], v1 offset:9216
  ds_read_b128 v[172:175], v1 offset:13824
  ds_read_b128 v[176:179], v1 offset:18432
  ds_read_b128 v[180:183], v1 offset:23040
  ds_read_b128 v[184:187], v1 offset:27648
  ds_read_b128 v[188:191], v1 offset:32256
  s_waitcnt lgkmcnt(6)
  v_add_f32 v112, v112, v160
  v_add_f32 v113, v113, v161
  v_add_f32 v114, v114, v162
  v_add_f32 v115, v115, v163
  v_add_f32 v116, v116, v164
  v_add_f32 v117, v117, v165
  v_add_f32 v118, v118, v166
  v_add_f32 v119, v119, v167
  s_waitcnt lgkmcnt(4)
  v_add_f32 v112, v112, v168
  v_add_f32 v113, v113, v169
  v_add_f32 v114, v114, v170
  v_add_f32 v115, v115, v171
  v_add_f32 v116, v116, v172
  v_add_f32 v117, v117, v173
  v_add_f32 v118, v118, v174
  v_add_f32 v119, v119, v175
  s_waitcnt lgkmcnt(2)
  v_add_f32 v112, v112, v176
  v_add_f32 v113, v113, v177
  v_add_f32 v114, v114, v178
  v_add_f32 v115, v115, v179
  v_add_f32 v116, v116, v180
  v_add_f32 v117, v117, v181
  v_add_f32 v118, v118, v182
  v_add_f32 v119, v119, v183
  s_waitcnt lgkmcnt(0)
  v_add_f32 v112, v112, v184
  v_add_f32 v113, v113, v185
  v_add_f32 v114, v114, v186
  v_add_f32 v115, v115, v187
  v_add_f32 v116, v116, v188
  v_add_f32 v117, v117, v189
  v_add_f32 v118, v118, v190
  v_add_f32 v119, v119, v191
  s_barrier
  ds_read_b64_tr_b16 v[208:209], v32 offset:0
  ds_read_b64_tr_b16 v[210:211], v32 offset:1024
  ds_read_b64_tr_b16 v[212:213], v33 offset:0
  ds_read_b64_tr_b16 v[214:215], v33 offset:1024
  ds_read_b64_tr_b16 v[216:217], v34 offset:0
  ds_read_b64_tr_b16 v[218:219], v34 offset:1024
  ds_read_b64_tr_b16 v[220:221], v35 offset:0
  ds_read_b64_tr_b16 v[222:223], v35 offset:1024
  s_waitcnt lgkmcnt(6)
  v_lshlrev_b32 v40, 16, v208
  v_and_b32 v41, 0xffff0000, v208
  v_lshlrev_b32 v42, 16, v209
  v_and_b32 v43, 0xffff0000, v209
  v_lshlrev_b32 v44, 16, v210
  v_and_b32 v45, 0xffff0000, v210
  v_lshlrev_b32 v46, 16, v211
  v_and_b32 v47, 0xffff0000, v211
  v_fma_f32 v40, v40, v128, v96
  v_fma_f32 v41, v41, v129, v97
  v_fma_f32 v42, v42, v130, v98
  v_fma_f32 v43, v43, v131, v99
  v_fma_f32 v44, v44, v132, v100
  v_fma_f32 v45, v45, v133, v101
  v_fma_f32 v46, v46, v134, v102
  v_fma_f32 v47, v47, v135, v103
  v_cvt_pk_bf16_f32 v240, v40, v41
  v_cvt_pk_bf16_f32 v241, v42, v43
  v_cvt_pk_bf16_f32 v242, v44, v45
  v_cvt_pk_bf16_f32 v243, v46, v47
  ds_write_b128 v7, v[240:243] offset:0
  ds_read_b128 v[192:195], v10 offset:0
  s_waitcnt lgkmcnt(6)
  v_lshlrev_b32 v40, 16, v212
  v_and_b32 v41, 0xffff0000, v212
  v_lshlrev_b32 v42, 16, v213
  v_and_b32 v43, 0xffff0000, v213
  v_lshlrev_b32 v44, 16, v214
  v_and_b32 v45, 0xffff0000, v214
  v_lshlrev_b32 v46, 16, v215
  v_and_b32 v47, 0xffff0000, v215
  v_fma_f32 v40, v40, v136, v104
  v_fma_f32 v41, v41, v137, v105
  v_fma_f32 v42, v42, v138, v106
  v_fma_f32 v43, v43, v139, v107
  v_fma_f32 v44, v44, v140, v108
  v_fma_f32 v45, v45, v141, v109
  v_fma_f32 v46, v46, v142, v110
  v_fma_f32 v47, v47, v143, v111
  v_cvt_pk_bf16_f32 v244, v40, v41
  v_cvt_pk_bf16_f32 v245, v42, v43
  v_cvt_pk_bf16_f32 v246, v44, v45
  v_cvt_pk_bf16_f32 v247, v46, v47
  ds_write_b128 v7, v[244:247] offset:1280
  ds_read_b128 v[196:199], v10 offset:1280
  s_waitcnt lgkmcnt(2)
  s_mov_b32 s78, 0
  buffer_store_dwordx4 v[192:195], v2, s[44:47], s78 offen sc1
  v_lshlrev_b32 v40, 16, v216
  v_and_b32 v41, 0xffff0000, v216
  v_lshlrev_b32 v42, 16, v217
  v_and_b32 v43, 0xffff0000, v217
  v_lshlrev_b32 v44, 16, v218
  v_and_b32 v45, 0xffff0000, v218
  v_lshlrev_b32 v46, 16, v219
  v_and_b32 v47, 0xffff0000, v219
  v_fma_f32 v40, v40, v144, v112
  v_fma_f32 v41, v41, v145, v113
  v_fma_f32 v42, v42, v146, v114
  v_fma_f32 v43, v43, v147, v115
  v_fma_f32 v44, v44, v148, v116
  v_fma_f32 v45, v45, v149, v117
  v_fma_f32 v46, v46, v150, v118
  v_fma_f32 v47, v47, v151, v119
  v_cvt_pk_bf16_f32 v248, v40, v41
  v_cvt_pk_bf16_f32 v249, v42, v43
  v_cvt_pk_bf16_f32 v250, v44, v45
  v_cvt_pk_bf16_f32 v251, v46, v47
  ds_write_b128 v7, v[248:251] offset:2560
  ds_read_b128 v[200:203], v10 offset:2560
  s_waitcnt lgkmcnt(2)
  s_mov_b32 s78, 81920
  buffer_store_dwordx4 v[196:199], v2, s[44:47], s78 offen sc1
  s_waitcnt lgkmcnt(0)
  s_mov_b32 s78, 163840
  buffer_store_dwordx4 v[200:203], v2, s[44:47], s78 offen sc1
  s_barrier
  v_add_u32 v1, 36864, v1
  ds_read_b128 v[160:163], v1 offset:0
  ds_read_b128 v[164:167], v1 offset:4608
  ds_read_b128 v[168:171], v1 offset:9216
  ds_read_b128 v[172:175], v1 offset:13824
  ds_read_b128 v[176:179], v1 offset:18432
  ds_read_b128 v[180:183], v1 offset:23040
  ds_read_b128 v[184:187], v1 offset:27648
  ds_read_b128 v[188:191], v1 offset:32256
  s_waitcnt lgkmcnt(6)
  v_pk_add_f32 v[120:121], v[120:121], v[160:161]
  v_pk_add_f32 v[122:123], v[122:123], v[162:163]
  v_pk_add_f32 v[124:125], v[124:125], v[164:165]
  v_pk_add_f32 v[126:127], v[126:127], v[166:167]
  s_waitcnt lgkmcnt(4)
  v_pk_add_f32 v[120:121], v[120:121], v[168:169]
  v_pk_add_f32 v[122:123], v[122:123], v[170:171]
  v_pk_add_f32 v[124:125], v[124:125], v[172:173]
  v_pk_add_f32 v[126:127], v[126:127], v[174:175]
  s_waitcnt lgkmcnt(2)
  v_pk_add_f32 v[120:121], v[120:121], v[176:177]
  v_pk_add_f32 v[122:123], v[122:123], v[178:179]
  v_pk_add_f32 v[124:125], v[124:125], v[180:181]
  v_pk_add_f32 v[126:127], v[126:127], v[182:183]
  s_waitcnt lgkmcnt(0)
  v_pk_add_f32 v[120:121], v[120:121], v[184:185]
  v_pk_add_f32 v[122:123], v[122:123], v[186:187]
  v_pk_add_f32 v[124:125], v[124:125], v[188:189]
  v_pk_add_f32 v[126:127], v[126:127], v[190:191]
  v_lshlrev_b32 v40, 16, v220
  v_and_b32 v41, 0xffff0000, v220
  v_lshlrev_b32 v42, 16, v221
  v_and_b32 v43, 0xffff0000, v221
  v_lshlrev_b32 v44, 16, v222
  v_and_b32 v45, 0xffff0000, v222
  v_lshlrev_b32 v46, 16, v223
  v_and_b32 v47, 0xffff0000, v223
  v_pk_fma_f32 v[40:41], v[40:41], v[152:153], v[120:121]
  v_pk_fma_f32 v[42:43], v[42:43], v[154:155], v[122:123]
  v_pk_fma_f32 v[44:45], v[44:45], v[156:157], v[124:125]
  v_pk_fma_f32 v[46:47], v[46:47], v[158:159], v[126:127]
  v_cvt_pk_bf16_f32 v252, v40, v41
  v_cvt_pk_bf16_f32 v253, v42, v43
  v_cvt_pk_bf16_f32 v254, v44, v45
  v_cvt_pk_bf16_f32 v255, v46, v47
  ds_write_b128 v7, v[252:255] offset:3840
  ds_read_b128 v[204:207], v10 offset:3840
  s_waitcnt lgkmcnt(0)
  s_mov_b32 s78, 245760
  buffer_store_dwordx4 v[204:207], v2, s[44:47], s78 offen sc1
  s_branch L_fin
L_role_c:
  s_lshl_b32 s76, s72, 12
  s_add_u32 s48, s16, s76
  s_addc_u32 s49, s17, 0
  s_mov_b32 s50, 4096
  s_mov_b32 s51, 0x20000
  s_mul_i32 s77, s72, 4224
  s_add_u32 s76, s77, 262144
  s_add_u32 s52, s32, s76
  s_addc_u32 s53, s33, 0
  s_mov_b32 s54, 4096
  s_mov_b32 s55, 0x20000
  s_add_u32 s35, s77, 3014656
  s_lshr_b32 s76, s72, 1
  s_lshl_b32 s76, s76, 2
  s_load_dword s75, s[18:19], s76
  v_lshlrev_b32 v192, 4, v0
  v_subrev_u32 v193, 4, v192
  v_add_u32 v194, 2, v192
  v_add_u32 v202, s73, v192
  v_mov_b32 v204, s73
  v_cmp_gt_u32 vcc, 4, v0
  v_lshlrev_b32 v196, 4, v0
  v_mov_b32 v195, 0x7fffffff
  v_cndmask_b32 v195, v195, v196, vcc
  v_mov_b32 v196, s63
  v_bfe_u32 v199, v0, 2, 1
  v_mul_u32_u24 v199, 4224, v199
  v_bfe_u32 v20, v0, 4, 2
  v_lshlrev_b32 v20, 4, v20
  v_add_u32 v199, v199, v20
  v_and_b32 v20, 3, v0
  v_lshlrev_b32 v20, 4, v20
  v_add_u32 v199, v199, v20
  v_bfe_u32 v20, v0, 3, 1
  v_lshlrev_b32 v20, 6, v20
  v_add_u32 v199, v199, v20
  v_add_u32 v199, s73, v199
  v_bfe_u32 v201, v0, 4, 2
  v_lshlrev_b32 v201, 4, v201
  v_and_b32 v20, 1, v0
  v_mul_u32_u24 v20, 4672, v20
  v_sub_u32 v201, v201, v20
  v_bfe_u32 v20, v0, 1, 1
  v_lshlrev_b32 v20, 3, v20
  v_sub_u32 v201, v201, v20
  v_bfe_u32 v20, v0, 2, 2
  v_lshlrev_b32 v20, 7, v20
  v_sub_u32 v201, v201, v20
  v_add_u32 v201, s73, v201
  v_add_u32 v201, 13512, v201
  v_bfe_u32 v203, v0, 2, 1
  v_lshlrev_b32 v203, 9, v203
  v_bfe_u32 v20, v0, 3, 1
  v_lshlrev_b32 v20, 8, v20
  v_add_u32 v203, v203, v20
  v_bfe_u32 v20, v0, 4, 2
  v_lshlrev_b32 v20, 6, v20
  v_add_u32 v203, v203, v20
  v_and_b32 v20, 3, v0
  v_lshlrev_b32 v20, 4, v20
  v_add_u32 v203, v203, v20
  v_mov_b32 v12, 0
  v_mov_b32 v13, 0
  v_mov_b32 v14, 0
  v_mov_b32 v15, 0
  v_mov_b32 v20, 141312
  ds_write_b128 v20, v[12:15]
  ds_write_b128 v20, v[12:15] offset:16
  v_mov_b32 v22, 0
  v_mov_b32 v23, 0
  s_mov_b32 s77, 0x3f803f80
  s_waitcnt vmcnt(6)
  v_dot2c_f32_bf16 v22, s77, v136
  v_dot2c_f32_bf16 v23, v136, v136
  v_dot2c_f32_bf16 v22, s77, v137
  v_dot2c_f32_bf16 v23, v137, v137
  v_dot2c_f32_bf16 v22, s77, v138
  v_dot2c_f32_bf16 v23, v138, v138
  v_dot2c_f32_bf16 v22, s77, v139
  v_dot2c_f32_bf16 v23, v139, v139
  s_waitcnt vmcnt(5)
  v_dot2c_f32_bf16 v22, s77, v140
  v_dot2c_f32_bf16 v23, v140, v140
  v_dot2c_f32_bf16 v22, s77, v141
  v_dot2c_f32_bf16 v23, v141, v141
  v_dot2c_f32_bf16 v22, s77, v142
  v_dot2c_f32_bf16 v23, v142, v142
  v_dot2c_f32_bf16 v22, s77, v143
  v_dot2c_f32_bf16 v23, v143, v143
  s_waitcnt vmcnt(4)
  v_dot2c_f32_bf16 v22, s77, v144
  v_dot2c_f32_bf16 v23, v144, v144
  v_dot2c_f32_bf16 v22, s77, v145
  v_dot2c_f32_bf16 v23, v145, v145
  v_dot2c_f32_bf16 v22, s77, v146
  v_dot2c_f32_bf16 v23, v146, v146
  v_dot2c_f32_bf16 v22, s77, v147
  v_dot2c_f32_bf16 v23, v147, v147
  s_waitcnt vmcnt(3)
  v_dot2c_f32_bf16 v22, s77, v148
  v_dot2c_f32_bf16 v23, v148, v148
  v_dot2c_f32_bf16 v22, s77, v149
  v_dot2c_f32_bf16 v23, v149, v149
  v_dot2c_f32_bf16 v22, s77, v150
  v_dot2c_f32_bf16 v23, v150, v150
  v_dot2c_f32_bf16 v22, s77, v151
  v_dot2c_f32_bf16 v23, v151, v151
  s_waitcnt vmcnt(2)
  v_dot2c_f32_bf16 v22, s77, v152
  v_dot2c_f32_bf16 v23, v152, v152
  v_dot2c_f32_bf16 v22, s77, v153
  v_dot2c_f32_bf16 v23, v153, v153
  v_dot2c_f32_bf16 v22, s77, v154
  v_dot2c_f32_bf16 v23, v154, v154
  v_dot2c_f32_bf16 v22, s77, v155
  v_dot2c_f32_bf16 v23, v155, v155
  s_nop 1
  v_add_f32_dpp v22, v22, v22 quad_perm:[1,0,3,2] row_mask:0xf bank_mask:0xf
  v_add_f32_dpp v23, v23, v23 quad_perm:[1,0,3,2] row_mask:0xf bank_mask:0xf
  s_nop 0
  v_add_f32_dpp v22, v22, v22 quad_perm:[2,3,0,1] row_mask:0xf bank_mask:0xf
  v_add_f32_dpp v23, v23, v23 quad_perm:[2,3,0,1] row_mask:0xf bank_mask:0xf
  s_nop 0
  v_add_f32_dpp v22, v22, v22 row_half_mirror row_mask:0xf bank_mask:0xf
  v_add_f32_dpp v23, v23, v23 row_half_mirror row_mask:0xf bank_mask:0xf
  s_nop 0
  v_add_f32_dpp v22, v22, v22 row_mirror row_mask:0xf bank_mask:0xf
  v_add_f32_dpp v23, v23, v23 row_mirror row_mask:0xf bank_mask:0xf
  v_mul_f32 v22, 0x3acccccd, v22
  v_mul_f32 v23, 0x3acccccd, v23
  v_fma_f32 v23, -v22, v22, v23
  v_max_f32 v23, 0, v23
  v_sub_f32 v22, 0, v22
  v_cvt_pk_bf16_f32 v24, v22, v22
  v_cvt_pk_bf16_f32 v23, v23, v23
  v_and_b32 v23, 0xffff0000, v23
  v_add_f32 v23, 0x3727c5ac, v23
  v_cvt_pk_bf16_f32 v23, v23, v23
  v_and_b32 v23, 0xffff0000, v23
  v_sqrt_f32 v23, v23
  v_mov_b32 v25, s63
  v_cvt_pk_bf16_f32 v23, v23, v23
  v_and_b32 v23, 0xffff0000, v23
  v_rcp_f32 v26, v23
  v_mul_f32 v27, v23, v23
  v_mul_f32 v26, 0xbfb8aa3b, v26
  v_and_b32 v21, 15, v0
  v_cmp_eq_u32 vcc, 0, v21
  v_mov_b32 v21, 0x7fffffff
  s_nop 0
  v_cndmask_b32 v21, v21, v0, vcc
  s_lshl_b32 s76, s69, 7
  s_add_u32 s76, s76, 12845056
  buffer_store_dwordx4 v[24:27], v21, s[36:39], s76 offen sc1
  s_waitcnt vmcnt(1)
  s_waitcnt lgkmcnt(0)
  s_barrier
  s_and_b32 s76, s60, 3
  s_cmp_lg_u32 s76, 0
  s_cbranch_scc1 L_c_noflag
  buffer_store_dwordx4 v[196:199], v195, s[36:39], s4 offen sc1
L_c_noflag:
  s_cmp_ge_u32 s60, 4
  s_cbranch_scc1 L_hlate_24
  s_add_u32 m0, s73, 4336
  s_nop 0
  buffer_load_dwordx4 v192, s[48:51], 0 offen offset:0 nt lds
  buffer_load_dwordx4 v192, s[48:51], 0 offen offset:1024 nt lds
  buffer_load_dwordx4 v192, s[48:51], 0 offen offset:2048 nt lds
  buffer_load_dwordx4 v192, s[48:51], 0 offen offset:3072 nt lds
  s_add_u32 m0, s73, 112
  s_nop 0
  buffer_load_dwordx4 v193, s[48:51], 0 offen offset:0  lds
  s_movk_i32 s76, 1020
  s_add_u32 m0, s73, 1136
  s_nop 0
  buffer_load_dwordx4 v192, s[48:51], s76 offen offset:0  lds
  buffer_load_dwordx4 v192, s[48:51], s76 offen offset:1024  lds
  buffer_load_dwordx4 v192, s[48:51], s76 offen offset:2048  lds
L_hlate_24:
  s_mov_b32 exec_lo, 0x0fffffff
  s_mov_b32 exec_hi, 0
  ds_write_b128 v202, v[12:15] offset:12544
  ds_write_b128 v202, v[12:15] offset:17216
  s_mov_b32 exec_lo, 0x7f
  ds_write_b128 v202, v[12:15] offset:0
  ds_write_b128 v202, v[12:15] offset:4224
  s_mov_b64 exec, -1
  v_mov_b64 v[32:33], 0
  v_mov_b64 v[34:35], 0
  v_mov_b64 v[36:37], 0
  v_mov_b64 v[38:39], 0
  v_mov_b64 v[40:41], 0
  v_mov_b64 v[42:43], 0
  v_mov_b64 v[44:45], 0
  v_mov_b64 v[46:47], 0
  v_mov_b64 v[48:49], 0
  v_mov_b64 v[50:51], 0
  v_mov_b64 v[52:53], 0
  v_mov_b64 v[54:55], 0
  v_mov_b64 v[56:57], 0
  v_mov_b64 v[58:59], 0
  v_mov_b64 v[60:61], 0
  v_mov_b64 v[62:63], 0
  s_mov_b32 s40, s26
  s_mov_b32 s41, s27
  s_mov_b32 s42, 1966080
  s_mov_b32 s43, 0x20000
  s_lshr_b32 s76, s66, 1
  s_mul_i32 s76, s76, 6
  s_add_u32 s76, s76, s60
  s_and_b32 s77, s66, 1
  s_lshl1_add_u32 s76, s76, s77
  s_mul_i32 s76, s76, 40960
  s_bfe_u32 s77, s61, 0x10001
  s_mul_i32 s77, s77, 640
  s_add_u32 s6, s76, s77
  s_cmp_ge_u32 s60, 6
  s_cselect_b32 s42, 0, s42
  v_add_u32 v21, 0, v0
  v_min_u32 v21, 159, v21
  v_mul_u32_u24 v22, 52429, v21
  v_lshrrev_b32 v22, 18, v22
  v_mul_u32_u24 v23, 640, v22
  v_lshl_add_u32 v16, v21, 7, v23
  v_add_u32 v21, 64, v0
  v_min_u32 v21, 159, v21
  v_mul_u32_u24 v22, 52429, v21
  v_lshrrev_b32 v22, 18, v22
  v_mul_u32_u24 v23, 640, v22
  v_lshl_add_u32 v17, v21, 7, v23
  v_add_u32 v21, 128, v0
  v_min_u32 v21, 159, v21
  v_mul_u32_u24 v22, 52429, v21
  v_lshrrev_b32 v22, 18, v22
  v_mul_u32_u24 v23, 640, v22
  v_lshl_add_u32 v18, v21, 7, v23
  s_cmp_ge_u32 s60, 4
  s_cbranch_scc1 L_c_late
  s_waitcnt vmcnt(0)
  ds_read_b128 v[24:27], v204 offset:4336
  s_waitcnt lgkmcnt(0)
  s_and_b32 s76, s72, 1
  s_lshl_b32 s77, s75, 16
  s_and_b32 s75, s75, 0xffff0000
  s_cmp_eq_u32 s76, 0
  s_cselect_b32 s75, s77, s75
  v_lshlrev_b32 v20, 16, v24
  v_and_b32 v21, 0xffff0000, v24
  v_add_f32 v20, s75, v20
  v_cvt_pk_bf16_f32 v21, v20, v21
  v_mov_b32 v20, 0
  v_mov_b32 v22, v25
  v_mov_b32 v23, v26
  s_mov_b64 exec, 1
  ds_write_b32 v204, v21 offset:4336
  ds_write_b128 v204, v[20:23] offset:112
  s_mov_b64 exec, -1
  s_cmp_lg_u32 s60, 0
  s_cbranch_scc1 L_c_nopoll
  s_lshr_b32 s78, s72, 6
  s_lshl_b32 s78, s78, 12
  s_add_u32 s78, s78, 81920
  v_and_b32 v197, 31, v0
  v_lshlrev_b32 v197, 7, v197
  s_mov_b32 s71, 0
L_poll_25:
  buffer_load_dword v198, v197, s[36:39], s78 offen sc1
  s_add_u32 s71, s71, 1
  s_cmp_ge_u32 s71, 200000
  s_waitcnt vmcnt(0)
  s_cbranch_scc1 L_ready_27
L_chk_26:
  v_cmp_ne_u32 vcc, s63, v198
  s_nop 1
  s_cbranch_vccnz L_poll_25
L_ready_27:
L_c_nopoll:
  s_barrier
  s_add_u32 m0, s73, 8448
  s_nop 0
  buffer_load_dwordx4 v192, s[52:55], 0 offen offset:0 sc1 lds
  buffer_load_dwordx4 v192, s[52:55], 0 offen offset:1024 sc1 lds
  buffer_load_dwordx4 v192, s[52:55], 0 offen offset:2048 sc1 lds
  buffer_load_dwordx4 v192, s[52:55], 0 offen offset:3072 sc1 lds
  s_branch L_c_join
L_c_late:
  s_barrier
  s_add_u32 m0, s73, 4336
  s_nop 0
  buffer_load_dwordx4 v192, s[48:51], 0 offen offset:0 nt lds
  buffer_load_dwordx4 v192, s[48:51], 0 offen offset:1024 nt lds
  buffer_load_dwordx4 v192, s[48:51], 0 offen offset:2048 nt lds
  buffer_load_dwordx4 v192, s[48:51], 0 offen offset:3072 nt lds
  s_add_u32 m0, s73, 112
  s_nop 0
  buffer_load_dwordx4 v193, s[48:51], 0 offen offset:0  lds
  s_movk_i32 s76, 1020
  s_add_u32 m0, s73, 1136
  s_nop 0
  buffer_load_dwordx4 v192, s[48:51], s76 offen offset:0  lds
  buffer_load_dwordx4 v192, s[48:51], s76 offen offset:1024  lds
  buffer_load_dwordx4 v192, s[48:51], s76 offen offset:2048  lds
  s_add_u32 m0, s73, 8448
  s_nop 0
  buffer_load_dwordx4 v192, s[52:55], 0 offen offset:0 sc1 lds
  buffer_load_dwordx4 v192, s[52:55], 0 offen offset:1024 sc1 lds
  buffer_load_dwordx4 v192, s[52:55], 0 offen offset:2048 sc1 lds
  buffer_load_dwordx4 v192, s[52:55], 0 offen offset:3072 sc1 lds
  s_waitcnt vmcnt(4)
  ds_read_b128 v[24:27], v204 offset:4336
  s_waitcnt lgkmcnt(0)
  s_and_b32 s76, s72, 1
  s_lshl_b32 s77, s75, 16
  s_and_b32 s75, s75, 0xffff0000
  s_cmp_eq_u32 s76, 0
  s_cselect_b32 s75, s77, s75
  v_lshlrev_b32 v20, 16, v24
  v_and_b32 v21, 0xffff0000, v24
  v_add_f32 v20, s75, v20
  v_cvt_pk_bf16_f32 v21, v20, v21
  v_mov_b32 v20, 0
  v_mov_b32 v22, v25
  v_mov_b32 v23, v26
  s_mov_b64 exec, 1
  ds_write_b32 v204, v21 offset:4336
  ds_write_b128 v204, v[20:23] offset:112
  s_mov_b64 exec, -1
L_c_join:
  s_waitcnt vmcnt(0)
  ds_read_b128 v[64:67], v202 offset:8448
  ds_read_b32 v68, v202 offset:8464
  ds_read_b128 v[72:75], v202 offset:9472
  ds_read_b32 v76, v202 offset:9488
  ds_read_b128 v[80:83], v202 offset:10496
  ds_read_b32 v84, v202 offset:10512
  ds_read_b128 v[88:91], v202 offset:11520
  ds_read_b32 v92, v202 offset:11536
  s_waitcnt lgkmcnt(6)
  v_alignbit_b32 v96, v65, v64, 16
  v_alignbit_b32 v97, v66, v65, 16
  v_alignbit_b32 v98, v67, v66, 16
  v_alignbit_b32 v99, v68, v67, 16
  ds_write_b128 v202, v[96:99] offset:13120
  s_waitcnt lgkmcnt(5)
  v_alignbit_b32 v100, v73, v72, 16
  v_alignbit_b32 v101, v74, v73, 16
  v_alignbit_b32 v102, v75, v74, 16
  v_alignbit_b32 v103, v76, v75, 16
  ds_write_b128 v202, v[100:103] offset:14144
  s_waitcnt lgkmcnt(4)
  v_alignbit_b32 v104, v81, v80, 16
  v_alignbit_b32 v105, v82, v81, 16
  v_alignbit_b32 v106, v83, v82, 16
  v_alignbit_b32 v107, v84, v83, 16
  ds_write_b128 v202, v[104:107] offset:15168
  s_waitcnt lgkmcnt(3)
  v_alignbit_b32 v108, v89, v88, 16
  v_alignbit_b32 v109, v90, v89, 16
  v_alignbit_b32 v110, v91, v90, 16
  v_alignbit_b32 v111, v92, v91, 16
  ds_write_b128 v202, v[108:111] offset:16192
  buffer_load_dword v200, v16, s[40:43], s6 offen
  buffer_load_dword v200, v17, s[40:43], s6 offen
  buffer_load_dword v200, v18, s[40:43], s6 offen
  s_waitcnt lgkmcnt(0)
  ds_read_b128 v[64:67], v199 offset:0
  ds_read_b64 v[128:129], v201 offset:3584
  ds_read_b64 v[130:131], v201 offset:3592
  ds_read_b128 v[68:71], v199 offset:512
  ds_read_b64 v[132:133], v201 offset:3072
  ds_read_b64 v[134:135], v201 offset:3080
  ds_read_b128 v[72:75], v199 offset:1024
  ds_read_b64 v[136:137], v201 offset:2560
  ds_read_b64 v[138:139], v201 offset:2568
  ds_read_b128 v[76:79], v199 offset:1536
  ds_read_b64 v[140:141], v201 offset:2048
  ds_read_b64 v[142:143], v201 offset:2056
  s_waitcnt lgkmcnt(4)
  ds_read_b128 v[80:83], v199 offset:2048
  ds_read_b64 v[144:145], v201 offset:1536
  ds_read_b64 v[146:147], v201 offset:1544
  ds_read_b128 v[84:87], v199 offset:2560
  ds_read_b64 v[148:149], v201 offset:1024
  ds_read_b64 v[150:151], v201 offset:1032
  ds_read_b128 v[88:91], v199 offset:3072
  ds_read_b64 v[152:153], v201 offset:512
  ds_read_b64 v[154:155], v201 offset:520
  ds_read_b128 v[92:95], v199 offset:3584
  ds_read_b64 v[156:157], v201 offset:0
  s_waitcnt lgkmcnt(13)
  ds_read_b64 v[158:159], v201 offset:8
  s_mov_b32 s71, 0
L_conv_loop0:
  v_add_u32 v199, 64, v199
  v_add_u32 v201, 64, v201
  s_waitcnt lgkmcnt(0)
  v_mfma_f32_16x16x32_bf16 v[32:35], v[128:131], v[64:67], v[32:35]
  ds_read_b128 v[96:99], v199 offset:0
  v_mfma_f32_16x16x32_bf16 v[36:39], v[128:131], v[68:71], v[36:39]
  ds_read_b64 v[160:161], v201 offset:3584
  v_mfma_f32_16x16x32_bf16 v[36:39], v[132:135], v[64:67], v[36:39]
  ds_read_b64 v[162:163], v201 offset:3592
  v_mfma_f32_16x16x32_bf16 v[40:43], v[128:131], v[72:75], v[40:43]
  ds_read_b128 v[100:103], v199 offset:512
  v_mfma_f32_16x16x32_bf16 v[40:43], v[132:135], v[68:71], v[40:43]
  ds_read_b64 v[164:165], v201 offset:3072
  v_mfma_f32_16x16x32_bf16 v[40:43], v[136:139], v[64:67], v[40:43]
  ds_read_b64 v[166:167], v201 offset:3080
  v_mfma_f32_16x16x32_bf16 v[44:47], v[128:131], v[76:79], v[44:47]
  ds_read_b128 v[104:107], v199 offset:1024
  v_mfma_f32_16x16x32_bf16 v[44:47], v[132:135], v[72:75], v[44:47]
  ds_read_b64 v[168:169], v201 offset:2560
  v_mfma_f32_16x16x32_bf16 v[44:47], v[136:139], v[68:71], v[44:47]
  ds_read_b64 v[170:171], v201 offset:2568
  v_mfma_f32_16x16x32_bf16 v[44:47], v[140:143], v[64:67], v[44:47]
  ds_read_b128 v[108:111], v199 offset:1536
  v_mfma_f32_16x16x32_bf16 v[48:51], v[128:131], v[80:83], v[48:51]
  ds_read_b64 v[172:173], v201 offset:2048
  v_mfma_f32_16x16x32_bf16 v[48:51], v[132:135], v[76:79], v[48:51]
  ds_read_b64 v[174:175], v201 offset:2056
  s_waitcnt lgkmcnt(6)
  v_mfma_f32_16x16x32_bf16 v[48:51], v[136:139], v[72:75], v[48:51]
  ds_read_b128 v[112:115], v199 offset:2048
  v_mfma_f32_16x16x32_bf16 v[48:51], v[140:143], v[68:71], v[48:51]
  ds_read_b64 v[176:177], v201 offset:1536
  v_mfma_f32_16x16x32_bf16 v[48:51], v[144:147], v[64:67], v[48:51]
  ds_read_b64 v[178:179], v201 offset:1544
  v_mfma_f32_16x16x32_bf16 v[52:55], v[128:131], v[84:87], v[52:55]
  ds_read_b128 v[116:119], v199 offset:2560
  v_mfma_f32_16x16x32_bf16 v[52:55], v[132:135], v[80:83], v[52:55]
  ds_read_b64 v[180:181], v201 offset:1024
  v_mfma_f32_16x16x32_bf16 v[52:55], v[136:139], v[76:79], v[52:55]
  ds_read_b64 v[182:183], v201 offset:1032
  v_mfma_f32_16x16x32_bf16 v[52:55], v[140:143], v[72:75], v[52:55]
  ds_read_b128 v[120:123], v199 offset:3072
  v_mfma_f32_16x16x32_bf16 v[52:55], v[144:147], v[68:71], v[52:55]
  ds_read_b64 v[184:185], v201 offset:512
  s_waitcnt lgkmcnt(6)
  v_mfma_f32_16x16x32_bf16 v[52:55], v[148:151], v[64:67], v[52:55]
  ds_read_b64 v[186:187], v201 offset:520
  v_mfma_f32_16x16x32_bf16 v[56:59], v[128:131], v[88:91], v[56:59]
  ds_read_b128 v[124:127], v199 offset:3584
  v_mfma_f32_16x16x32_bf16 v[56:59], v[132:135], v[84:87], v[56:59]
  ds_read_b64 v[188:189], v201 offset:0
  v_mfma_f32_16x16x32_bf16 v[56:59], v[136:139], v[80:83], v[56:59]
  ds_read_b64 v[190:191], v201 offset:8
  v_mfma_f32_16x16x32_bf16 v[56:59], v[140:143], v[76:79], v[56:59]
  v_mfma_f32_16x16x32_bf16 v[56:59], v[144:147], v[72:75], v[56:59]
  v_mfma_f32_16x16x32_bf16 v[56:59], v[148:151], v[68:71], v[56:59]
  v_mfma_f32_16x16x32_bf16 v[56:59], v[152:155], v[64:67], v[56:59]
  v_mfma_f32_16x16x32_bf16 v[60:63], v[128:131], v[92:95], v[60:63]
  v_mfma_f32_16x16x32_bf16 v[60:63], v[132:135], v[88:91], v[60:63]
  v_mfma_f32_16x16x32_bf16 v[60:63], v[136:139], v[84:87], v[60:63]
  v_mfma_f32_16x16x32_bf16 v[60:63], v[140:143], v[80:83], v[60:63]
  v_mfma_f32_16x16x32_bf16 v[60:63], v[144:147], v[76:79], v[60:63]
  v_mfma_f32_16x16x32_bf16 v[60:63], v[148:151], v[72:75], v[60:63]
  v_mfma_f32_16x16x32_bf16 v[60:63], v[152:155], v[68:71], v[60:63]
  v_mfma_f32_16x16x32_bf16 v[60:63], v[156:159], v[64:67], v[60:63]
  v_add_u32 v199, 64, v199
  v_add_u32 v201, 64, v201
  s_waitcnt lgkmcnt(0)
  v_mfma_f32_16x16x32_bf16 v[32:35], v[160:163], v[96:99], v[32:35]
  ds_read_b128 v[64:67], v199 offset:0
  v_mfma_f32_16x16x32_bf16 v[36:39], v[160:163], v[100:103], v[36:39]
  ds_read_b64 v[128:129], v201 offset:3584
  v_mfma_f32_16x16x32_bf16 v[36:39], v[164:167], v[96:99], v[36:39]
  ds_read_b64 v[130:131], v201 offset:3592
  v_mfma_f32_16x16x32_bf16 v[40:43], v[160:163], v[104:107], v[40:43]
  ds_read_b128 v[68:71], v199 offset:512
  v_mfma_f32_16x16x32_bf16 v[40:43], v[164:167], v[100:103], v[40:43]
  ds_read_b64 v[132:133], v201 offset:3072
  v_mfma_f32_16x16x32_bf16 v[40:43], v[168:171], v[96:99], v[40:43]
  ds_read_b64 v[134:135], v201 offset:3080
  v_mfma_f32_16x16x32_bf16 v[44:47], v[160:163], v[108:111], v[44:47]
  ds_read_b128 v[72:75], v199 offset:1024
  v_mfma_f32_16x16x32_bf16 v[44:47], v[164:167], v[104:107], v[44:47]
  ds_read_b64 v[136:137], v201 offset:2560
  v_mfma_f32_16x16x32_bf16 v[44:47], v[168:171], v[100:103], v[44:47]
  ds_read_b64 v[138:139], v201 offset:2568
  v_mfma_f32_16x16x32_bf16 v[44:47], v[172:175], v[96:99], v[44:47]
  ds_read_b128 v[76:79], v199 offset:1536
  v_mfma_f32_16x16x32_bf16 v[48:51], v[160:163], v[112:115], v[48:51]
  ds_read_b64 v[140:141], v201 offset:2048
  v_mfma_f32_16x16x32_bf16 v[48:51], v[164:167], v[108:111], v[48:51]
  ds_read_b64 v[142:143], v201 offset:2056
  s_waitcnt lgkmcnt(6)
  v_mfma_f32_16x16x32_bf16 v[48:51], v[168:171], v[104:107], v[48:51]
  ds_read_b128 v[80:83], v199 offset:2048
  v_mfma_f32_16x16x32_bf16 v[48:51], v[172:175], v[100:103], v[48:51]
  ds_read_b64 v[144:145], v201 offset:1536
  v_mfma_f32_16x16x32_bf16 v[48:51], v[176:179], v[96:99], v[48:51]
  ds_read_b64 v[146:147], v201 offset:1544
  v_mfma_f32_16x16x32_bf16 v[52:55], v[160:163], v[116:119], v[52:55]
  ds_read_b128 v[84:87], v199 offset:2560
  v_mfma_f32_16x16x32_bf16 v[52:55], v[164:167], v[112:115], v[52:55]
  ds_read_b64 v[148:149], v201 offset:1024
  v_mfma_f32_16x16x32_bf16 v[52:55], v[168:171], v[108:111], v[52:55]
  ds_read_b64 v[150:151], v201 offset:1032
  v_mfma_f32_16x16x32_bf16 v[52:55], v[172:175], v[104:107], v[52:55]
  ds_read_b128 v[88:91], v199 offset:3072
  v_mfma_f32_16x16x32_bf16 v[52:55], v[176:179], v[100:103], v[52:55]
  ds_read_b64 v[152:153], v201 offset:512
  s_waitcnt lgkmcnt(6)
  v_mfma_f32_16x16x32_bf16 v[52:55], v[180:183], v[96:99], v[52:55]
  ds_read_b64 v[154:155], v201 offset:520
  v_mfma_f32_16x16x32_bf16 v[56:59], v[160:163], v[120:123], v[56:59]
  ds_read_b128 v[92:95], v199 offset:3584
  v_mfma_f32_16x16x32_bf16 v[56:59], v[164:167], v[116:119], v[56:59]
  ds_read_b64 v[156:157], v201 offset:0
  v_mfma_f32_16x16x32_bf16 v[56:59], v[168:171], v[112:115], v[56:59]
  ds_read_b64 v[158:159], v201 offset:8
  v_mfma_f32_16x16x32_bf16 v[56:59], v[172:175], v[108:111], v[56:59]
  v_mfma_f32_16x16x32_bf16 v[56:59], v[176:179], v[104:107], v[56:59]
  v_mfma_f32_16x16x32_bf16 v[56:59], v[180:183], v[100:103], v[56:59]
  v_mfma_f32_16x16x32_bf16 v[56:59], v[184:187], v[96:99], v[56:59]
  v_mfma_f32_16x16x32_bf16 v[60:63], v[160:163], v[124:127], v[60:63]
  v_mfma_f32_16x16x32_bf16 v[60:63], v[164:167], v[120:123], v[60:63]
  v_mfma_f32_16x16x32_bf16 v[60:63], v[168:171], v[116:119], v[60:63]
  v_mfma_f32_16x16x32_bf16 v[60:63], v[172:175], v[112:115], v[60:63]
  v_mfma_f32_16x16x32_bf16 v[60:63], v[176:179], v[108:111], v[60:63]
  v_mfma_f32_16x16x32_bf16 v[60:63], v[180:183], v[104:107], v[60:63]
  v_mfma_f32_16x16x32_bf16 v[60:63], v[184:187], v[100:103], v[60:63]
  v_mfma_f32_16x16x32_bf16 v[60:63], v[188:191], v[96:99], v[60:63]
  s_add_u32 s71, s71, 1
  s_cmp_lt_u32 s71, 4
  s_cbranch_scc1 L_conv_loop0
  s_waitcnt lgkmcnt(0)
  v_cvt_pk_bf16_f32 v96, v32, v33
  v_cvt_pk_bf16_f32 v98, v34, v35
  v_cvt_pk_bf16_f32 v97, v36, v37
  v_cvt_pk_bf16_f32 v99, v38, v39
  v_mov_b32 v22, v97
  v_mov_b32 v23, v99
  v_mov_b32_dpp v97, v96 row_shl:4 row_mask:0xf bank_mask:0x5
  v_mov_b32_dpp v99, v98 row_shl:4 row_mask:0xf bank_mask:0x5
  v_mov_b32_dpp v96, v22 row_shr:4 row_mask:0xf bank_mask:0xa
  v_mov_b32_dpp v98, v23 row_shr:4 row_mask:0xf bank_mask:0xa
  buffer_store_dwordx4 v[96:99], v203, s[36:39], s35 offen offset:0 sc1
  v_cvt_pk_bf16_f32 v100, v40, v41
  v_cvt_pk_bf16_f32 v102, v42, v43
  v_cvt_pk_bf16_f32 v101, v44, v45
  v_cvt_pk_bf16_f32 v103, v46, v47
  v_mov_b32 v22, v101
  v_mov_b32 v23, v103
  v_mov_b32_dpp v101, v100 row_shl:4 row_mask:0xf bank_mask:0x5
  v_mov_b32_dpp v103, v102 row_shl:4 row_mask:0xf bank_mask:0x5
  v_mov_b32_dpp v100, v22 row_shr:4 row_mask:0xf bank_mask:0xa
  v_mov_b32_dpp v102, v23 row_shr:4 row_mask:0xf bank_mask:0xa
  buffer_store_dwordx4 v[100:103], v203, s[36:39], s35 offen offset:1024 sc1
  v_cvt_pk_bf16_f32 v104, v48, v49
  v_cvt_pk_bf16_f32 v106, v50, v51
  v_cvt_pk_bf16_f32 v105, v52, v53
  v_cvt_pk_bf16_f32 v107, v54, v55
  v_mov_b32 v22, v105
  v_mov_b32 v23, v107
  v_mov_b32_dpp v105, v104 row_shl:4 row_mask:0xf bank_mask:0x5
  v_mov_b32_dpp v107, v106 row_shl:4 row_mask:0xf bank_mask:0x5
  v_mov_b32_dpp v104, v22 row_shr:4 row_mask:0xf bank_mask:0xa
  v_mov_b32_dpp v106, v23 row_shr:4 row_mask:0xf bank_mask:0xa
  buffer_store_dwordx4 v[104:107], v203, s[36:39], s35 offen offset:2048 sc1
  v_cvt_pk_bf16_f32 v108, v56, v57
  v_cvt_pk_bf16_f32 v110, v58, v59
  v_cvt_pk_bf16_f32 v109, v60, v61
  v_cvt_pk_bf16_f32 v111, v62, v63
  v_mov_b32 v22, v109
  v_mov_b32 v23, v111
  v_mov_b32_dpp v109, v108 row_shl:4 row_mask:0xf bank_mask:0x5
  v_mov_b32_dpp v111, v110 row_shl:4 row_mask:0xf bank_mask:0x5
  v_mov_b32_dpp v108, v22 row_shr:4 row_mask:0xf bank_mask:0xa
  v_mov_b32_dpp v110, v23 row_shr:4 row_mask:0xf bank_mask:0xa
  buffer_store_dwordx4 v[108:111], v203, s[36:39], s35 offen offset:3072 sc1
  s_lshr_b32 s79, s72, 1
  s_lshl_b32 s79, s79, 7
  s_add_u32 s79, s79, 131072
  s_lshr_b32 s76, s60, 1
  s_lshl_b32 s76, s76, 2
  s_add_u32 s76, s76, 141312
  v_mov_b32 v24, s76
  s_cmp_lt_u32 s60, 4
  s_cbranch_scc1 L_round1
  s_waitcnt vmcnt(0)
  v_mov_b32 v25, 1
  s_mov_b64 exec, 1
  ds_add_rtn_u32 v25, v24, v25 offset:0
  s_mov_b64 exec, -1
  s_waitcnt lgkmcnt(0)
  v_readfirstlane_b32 s71, v25
  s_nop 1
  s_cmp_lg_u32 s71, 1
  s_cbranch_scc1 L_notlast_28
  buffer_store_dwordx4 v[196:199], v195, s[36:39], s79 offen sc1
L_notlast_28:
  s_branch L_fin
L_round1:
  s_lshr_b32 s76, s60, 1
  s_lshl1_add_u32 s72, s65, s76
  s_add_u32 s72, s72, 512
  s_lshl_b32 s76, s72, 12
  s_add_u32 s48, s16, s76
  s_addc_u32 s49, s17, 0
  s_mov_b32 s50, 4096
  s_mov_b32 s51, 0x20000
  s_mul_i32 s77, s72, 4224
  s_add_u32 s76, s77, 262144
  s_add_u32 s52, s32, s76
  s_addc_u32 s53, s33, 0
  s_mov_b32 s54, 4096
  s_mov_b32 s55, 0x20000
  s_add_u32 s35, s77, 3014656
  s_lshr_b32 s76, s72, 1
  s_lshl_b32 s76, s76, 2
  s_load_dword s75, s[18:19], s76
  s_add_u32 m0, s73, 4336
  s_nop 0
  buffer_load_dwordx4 v192, s[48:51], 0 offen offset:0 nt lds
  buffer_load_dwordx4 v192, s[48:51], 0 offen offset:1024 nt lds
  buffer_load_dwordx4 v192, s[48:51], 0 offen offset:2048 nt lds
  buffer_load_dwordx4 v192, s[48:51], 0 offen offset:3072 nt lds
  s_add_u32 m0, s73, 112
  s_nop 0
  buffer_load_dwordx4 v193, s[48:51], 0 offen offset:0  lds
  s_movk_i32 s76, 1020
  s_add_u32 m0, s73, 1136
  s_nop 0
  buffer_load_dwordx4 v192, s[48:51], s76 offen offset:0  lds
  buffer_load_dwordx4 v192, s[48:51], s76 offen offset:1024  lds
  buffer_load_dwordx4 v192, s[48:51], s76 offen offset:2048  lds
  s_lshr_b32 s78, s72, 6
  s_lshl_b32 s78, s78, 12
  s_add_u32 s78, s78, 81920
  v_and_b32 v197, 31, v0
  v_lshlrev_b32 v197, 7, v197
  s_mov_b32 s71, 0
L_poll_29:
  buffer_load_dword v198, v197, s[36:39], s78 offen sc1
  s_add_u32 s71, s71, 1
  s_cmp_ge_u32 s71, 200000
  s_waitcnt vmcnt(0)
  s_cbranch_scc1 L_ready_31
L_chk_30:
  v_cmp_ne_u32 vcc, s63, v198
  s_nop 1
  s_cbranch_vccnz L_poll_29
L_ready_31:
  s_add_u32 m0, s73, 8448
  s_nop 0
  buffer_load_dwordx4 v192, s[52:55], 0 offen offset:0 sc1 lds
  buffer_load_dwordx4 v192, s[52:55], 0 offen offset:1024 sc1 lds
  buffer_load_dwordx4 v192, s[52:55], 0 offen offset:2048 sc1 lds
  buffer_load_dwordx4 v192, s[52:55], 0 offen offset:3072 sc1 lds
  s_and_b32 s76, s60, 1
  s_lshl_b32 s76, s76, 8
  s_sub_u32 s76, s76, 512
  v_add_u32 v199, s76, v199
  v_add_u32 v201, s76, v201
  v_mov_b32 v25, 1
  s_mov_b64 exec, 1
  ds_add_rtn_u32 v25, v24, v25 offset:0
  s_mov_b64 exec, -1
  s_waitcnt lgkmcnt(0)
  v_readfirstlane_b32 s71, v25
  s_nop 1
  s_cmp_lg_u32 s71, 1
  s_cbranch_scc1 L_notlast_32
  buffer_store_dwordx4 v[196:199], v195, s[36:39], s79 offen sc1
L_notlast_32:
  v_mov_b64 v[32:33], 0
  v_mov_b64 v[34:35], 0
  v_mov_b64 v[36:37], 0
  v_mov_b64 v[38:39], 0
  v_mov_b64 v[40:41], 0
  v_mov_b64 v[42:43], 0
  v_mov_b64 v[44:45], 0
  v_mov_b64 v[46:47], 0
  v_mov_b64 v[48:49], 0
  v_mov_b64 v[50:51], 0
  v_mov_b64 v[52:53], 0
  v_mov_b64 v[54:55], 0
  v_mov_b64 v[56:57], 0
  v_mov_b64 v[58:59], 0
  v_mov_b64 v[60:61], 0
  v_mov_b64 v[62:63], 0
  ds_read_b128 v[24:27], v204 offset:4336
  s_waitcnt lgkmcnt(0)
  s_and_b32 s76, s72, 1
  s_lshl_b32 s77, s75, 16
  s_and_b32 s75, s75, 0xffff0000
  s_cmp_eq_u32 s76, 0
  s_cselect_b32 s75, s77, s75
  v_lshlrev_b32 v20, 16, v24
  v_and_b32 v21, 0xffff0000, v24
  v_add_f32 v20, s75, v20
  v_cvt_pk_bf16_f32 v21, v20, v21
  v_mov_b32 v20, 0
  v_mov_b32 v22, v25
  v_mov_b32 v23, v26
  s_mov_b64 exec, 1
  ds_write_b32 v204, v21 offset:4336
  ds_write_b128 v204, v[20:23] offset:112
  s_mov_b64 exec, -1
  s_waitcnt vmcnt(0)
  ds_read_b128 v[64:67], v202 offset:8448
  ds_read_b32 v68, v202 offset:8464
  ds_read_b128 v[72:75], v202 offset:9472
  ds_read_b32 v76, v202 offset:9488
  ds_read_b128 v[80:83], v202 offset:10496
  ds_read_b32 v84, v202 offset:10512
  ds_read_b128 v[88:91], v202 offset:11520
  ds_read_b32 v92, v202 offset:11536
  s_waitcnt lgkmcnt(6)
  v_alignbit_b32 v96, v65, v64, 16
  v_alignbit_b32 v97, v66, v65, 16
  v_alignbit_b32 v98, v67, v66, 16
  v_alignbit_b32 v99, v68, v67, 16
  ds_write_b128 v202, v[96:99] offset:13120
  s_waitcnt lgkmcnt(5)
  v_alignbit_b32 v100, v73, v72, 16
  v_alignbit_b32 v101, v74, v73, 16
  v_alignbit_b32 v102, v75, v74, 16
  v_alignbit_b32 v103, v76, v75, 16
  ds_write_b128 v202, v[100:103] offset:14144
  s_waitcnt lgkmcnt(4)
  v_alignbit_b32 v104, v81, v80, 16
  v_alignbit_b32 v105, v82, v81, 16
  v_alignbit_b32 v106, v83, v82, 16
  v_alignbit_b32 v107, v84, v83, 16
  ds_write_b128 v202, v[104:107] offset:15168
  s_waitcnt lgkmcnt(3)
  v_alignbit_b32 v108, v89, v88, 16
  v_alignbit_b32 v109, v90, v89, 16
  v_alignbit_b32 v110, v91, v90, 16
  v_alignbit_b32 v111, v92, v91, 16
  ds_write_b128 v202, v[108:111] offset:16192
  s_waitcnt lgkmcnt(0)
  ds_read_b128 v[64:67], v199 offset:0
  ds_read_b64 v[128:129], v201 offset:3584
  ds_read_b64 v[130:131], v201 offset:3592
  ds_read_b128 v[68:71], v199 offset:512
  ds_read_b64 v[132:133], v201 offset:3072
  ds_read_b64 v[134:135], v201 offset:3080
  ds_read_b128 v[72:75], v199 offset:1024
  ds_read_b64 v[136:137], v201 offset:2560
  ds_read_b64 v[138:139], v201 offset:2568
  ds_read_b128 v[76:79], v199 offset:1536
  ds_read_b64 v[140:141], v201 offset:2048
  ds_read_b64 v[142:143], v201 offset:2056
  s_waitcnt lgkmcnt(4)
  ds_read_b128 v[80:83], v199 offset:2048
  ds_read_b64 v[144:145], v201 offset:1536
  ds_read_b64 v[146:147], v201 offset:1544
  ds_read_b128 v[84:87], v199 offset:2560
  ds_read_b64 v[148:149], v201 offset:1024
  ds_read_b64 v[150:151], v201 offset:1032
  ds_read_b128 v[88:91], v199 offset:3072
  ds_read_b64 v[152:153], v201 offset:512
  ds_read_b64 v[154:155], v201 offset:520
  ds_read_b128 v[92:95], v199 offset:3584
  ds_read_b64 v[156:157], v201 offset:0
  s_waitcnt lgkmcnt(13)
  ds_read_b64 v[158:159], v201 offset:8
  s_mov_b32 s71, 0
L_conv_loop1:
  v_add_u32 v199, 64, v199
  v_add_u32 v201, 64, v201
  s_waitcnt lgkmcnt(0)
  v_mfma_f32_16x16x32_bf16 v[32:35], v[128:131], v[64:67], v[32:35]
  ds_read_b128 v[96:99], v199 offset:0
  v_mfma_f32_16x16x32_bf16 v[36:39], v[128:131], v[68:71], v[36:39]
  ds_read_b64 v[160:161], v201 offset:3584
  v_mfma_f32_16x16x32_bf16 v[36:39], v[132:135], v[64:67], v[36:39]
  ds_read_b64 v[162:163], v201 offset:3592
  v_mfma_f32_16x16x32_bf16 v[40:43], v[128:131], v[72:75], v[40:43]
  ds_read_b128 v[100:103], v199 offset:512
  v_mfma_f32_16x16x32_bf16 v[40:43], v[132:135], v[68:71], v[40:43]
  ds_read_b64 v[164:165], v201 offset:3072
  v_mfma_f32_16x16x32_bf16 v[40:43], v[136:139], v[64:67], v[40:43]
  ds_read_b64 v[166:167], v201 offset:3080
  v_mfma_f32_16x16x32_bf16 v[44:47], v[128:131], v[76:79], v[44:47]
  ds_read_b128 v[104:107], v199 offset:1024
  v_mfma_f32_16x16x32_bf16 v[44:47], v[132:135], v[72:75], v[44:47]
  ds_read_b64 v[168:169], v201 offset:2560
  v_mfma_f32_16x16x32_bf16 v[44:47], v[136:139], v[68:71], v[44:47]
  ds_read_b64 v[170:171], v201 offset:2568
  v_mfma_f32_16x16x32_bf16 v[44:47], v[140:143], v[64:67], v[44:47]
  ds_read_b128 v[108:111], v199 offset:1536
  v_mfma_f32_16x16x32_bf16 v[48:51], v[128:131], v[80:83], v[48:51]
  ds_read_b64 v[172:173], v201 offset:2048
  v_mfma_f32_16x16x32_bf16 v[48:51], v[132:135], v[76:79], v[48:51]
  ds_read_b64 v[174:175], v201 offset:2056
  s_waitcnt lgkmcnt(6)
  v_mfma_f32_16x16x32_bf16 v[48:51], v[136:139], v[72:75], v[48:51]
  ds_read_b128 v[112:115], v199 offset:2048
  v_mfma_f32_16x16x32_bf16 v[48:51], v[140:143], v[68:71], v[48:51]
  ds_read_b64 v[176:177], v201 offset:1536
  v_mfma_f32_16x16x32_bf16 v[48:51], v[144:147], v[64:67], v[48:51]
  ds_read_b64 v[178:179], v201 offset:1544
  v_mfma_f32_16x16x32_bf16 v[52:55], v[128:131], v[84:87], v[52:55]
  ds_read_b128 v[116:119], v199 offset:2560
  v_mfma_f32_16x16x32_bf16 v[52:55], v[132:135], v[80:83], v[52:55]
  ds_read_b64 v[180:181], v201 offset:1024
  v_mfma_f32_16x16x32_bf16 v[52:55], v[136:139], v[76:79], v[52:55]
  ds_read_b64 v[182:183], v201 offset:1032
  v_mfma_f32_16x16x32_bf16 v[52:55], v[140:143], v[72:75], v[52:55]
  ds_read_b128 v[120:123], v199 offset:3072
  v_mfma_f32_16x16x32_bf16 v[52:55], v[144:147], v[68:71], v[52:55]
  ds_read_b64 v[184:185], v201 offset:512
  s_waitcnt lgkmcnt(6)
  v_mfma_f32_16x16x32_bf16 v[52:55], v[148:151], v[64:67], v[52:55]
  ds_read_b64 v[186:187], v201 offset:520
  v_mfma_f32_16x16x32_bf16 v[56:59], v[128:131], v[88:91], v[56:59]
  ds_read_b128 v[124:127], v199 offset:3584
  v_mfma_f32_16x16x32_bf16 v[56:59], v[132:135], v[84:87], v[56:59]
  ds_read_b64 v[188:189], v201 offset:0
  v_mfma_f32_16x16x32_bf16 v[56:59], v[136:139], v[80:83], v[56:59]
  ds_read_b64 v[190:191], v201 offset:8
  v_mfma_f32_16x16x32_bf16 v[56:59], v[140:143], v[76:79], v[56:59]
  v_mfma_f32_16x16x32_bf16 v[56:59], v[144:147], v[72:75], v[56:59]
  v_mfma_f32_16x16x32_bf16 v[56:59], v[148:151], v[68:71], v[56:59]
  v_mfma_f32_16x16x32_bf16 v[56:59], v[152:155], v[64:67], v[56:59]
  v_mfma_f32_16x16x32_bf16 v[60:63], v[128:131], v[92:95], v[60:63]
  v_mfma_f32_16x16x32_bf16 v[60:63], v[132:135], v[88:91], v[60:63]
  v_mfma_f32_16x16x32_bf16 v[60:63], v[136:139], v[84:87], v[60:63]
  v_mfma_f32_16x16x32_bf16 v[60:63], v[140:143], v[80:83], v[60:63]
  v_mfma_f32_16x16x32_bf16 v[60:63], v[144:147], v[76:79], v[60:63]
  v_mfma_f32_16x16x32_bf16 v[60:63], v[148:151], v[72:75], v[60:63]
  v_mfma_f32_16x16x32_bf16 v[60:63], v[152:155], v[68:71], v[60:63]
  v_mfma_f32_16x16x32_bf16 v[60:63], v[156:159], v[64:67], v[60:63]
  v_add_u32 v199, 64, v199
  v_add_u32 v201, 64, v201
  s_waitcnt lgkmcnt(0)
  v_mfma_f32_16x16x32_bf16 v[32:35], v[160:163], v[96:99], v[32:35]
  ds_read_b128 v[64:67], v199 offset:0
  v_mfma_f32_16x16x32_bf16 v[36:39], v[160:163], v[100:103], v[36:39]
  ds_read_b64 v[128:129], v201 offset:3584
  v_mfma_f32_16x16x32_bf16 v[36:39], v[164:167], v[96:99], v[36:39]
  ds_read_b64 v[130:131], v201 offset:3592
  v_mfma_f32_16x16x32_bf16 v[40:43], v[160:163], v[104:107], v[40:43]
  ds_read_b128 v[68:71], v199 offset:512
  v_mfma_f32_16x16x32_bf16 v[40:43], v[164:167], v[100:103], v[40:43]
  ds_read_b64 v[132:133], v201 offset:3072
  v_mfma_f32_16x16x32_bf16 v[40:43], v[168:171], v[96:99], v[40:43]
  ds_read_b64 v[134:135], v201 offset:3080
  v_mfma_f32_16x16x32_bf16 v[44:47], v[160:163], v[108:111], v[44:47]
  ds_read_b128 v[72:75], v199 offset:1024
  v_mfma_f32_16x16x32_bf16 v[44:47], v[164:167], v[104:107], v[44:47]
  ds_read_b64 v[136:137], v201 offset:2560
  v_mfma_f32_16x16x32_bf16 v[44:47], v[168:171], v[100:103], v[44:47]
  ds_read_b64 v[138:139], v201 offset:2568
  v_mfma_f32_16x16x32_bf16 v[44:47], v[172:175], v[96:99], v[44:47]
  ds_read_b128 v[76:79], v199 offset:1536
  v_mfma_f32_16x16x32_bf16 v[48:51], v[160:163], v[112:115], v[48:51]
  ds_read_b64 v[140:141], v201 offset:2048
  v_mfma_f32_16x16x32_bf16 v[48:51], v[164:167], v[108:111], v[48:51]
  ds_read_b64 v[142:143], v201 offset:2056
  s_waitcnt lgkmcnt(6)
  v_mfma_f32_16x16x32_bf16 v[48:51], v[168:171], v[104:107], v[48:51]
  ds_read_b128 v[80:83], v199 offset:2048
  v_mfma_f32_16x16x32_bf16 v[48:51], v[172:175], v[100:103], v[48:51]
  ds_read_b64 v[144:145], v201 offset:1536
  v_mfma_f32_16x16x32_bf16 v[48:51], v[176:179], v[96:99], v[48:51]
  ds_read_b64 v[146:147], v201 offset:1544
  v_mfma_f32_16x16x32_bf16 v[52:55], v[160:163], v[116:119], v[52:55]
  ds_read_b128 v[84:87], v199 offset:2560
  v_mfma_f32_16x16x32_bf16 v[52:55], v[164:167], v[112:115], v[52:55]
  ds_read_b64 v[148:149], v201 offset:1024
  v_mfma_f32_16x16x32_bf16 v[52:55], v[168:171], v[108:111], v[52:55]
  ds_read_b64 v[150:151], v201 offset:1032
  v_mfma_f32_16x16x32_bf16 v[52:55], v[172:175], v[104:107], v[52:55]
  ds_read_b128 v[88:91], v199 offset:3072
  v_mfma_f32_16x16x32_bf16 v[52:55], v[176:179], v[100:103], v[52:55]
  ds_read_b64 v[152:153], v201 offset:512
  s_waitcnt lgkmcnt(6)
  v_mfma_f32_16x16x32_bf16 v[52:55], v[180:183], v[96:99], v[52:55]
  ds_read_b64 v[154:155], v201 offset:520
  v_mfma_f32_16x16x32_bf16 v[56:59], v[160:163], v[120:123], v[56:59]
  ds_read_b128 v[92:95], v199 offset:3584
  v_mfma_f32_16x16x32_bf16 v[56:59], v[164:167], v[116:119], v[56:59]
  ds_read_b64 v[156:157], v201 offset:0
  v_mfma_f32_16x16x32_bf16 v[56:59], v[168:171], v[112:115], v[56:59]
  ds_read_b64 v[158:159], v201 offset:8
  v_mfma_f32_16x16x32_bf16 v[56:59], v[172:175], v[108:111], v[56:59]
  v_mfma_f32_16x16x32_bf16 v[56:59], v[176:179], v[104:107], v[56:59]
  v_mfma_f32_16x16x32_bf16 v[56:59], v[180:183], v[100:103], v[56:59]
  v_mfma_f32_16x16x32_bf16 v[56:59], v[184:187], v[96:99], v[56:59]
  v_mfma_f32_16x16x32_bf16 v[60:63], v[160:163], v[124:127], v[60:63]
  v_mfma_f32_16x16x32_bf16 v[60:63], v[164:167], v[120:123], v[60:63]
  v_mfma_f32_16x16x32_bf16 v[60:63], v[168:171], v[116:119], v[60:63]
  v_mfma_f32_16x16x32_bf16 v[60:63], v[172:175], v[112:115], v[60:63]
  v_mfma_f32_16x16x32_bf16 v[60:63], v[176:179], v[108:111], v[60:63]
  v_mfma_f32_16x16x32_bf16 v[60:63], v[180:183], v[104:107], v[60:63]
  v_mfma_f32_16x16x32_bf16 v[60:63], v[184:187], v[100:103], v[60:63]
  v_mfma_f32_16x16x32_bf16 v[60:63], v[188:191], v[96:99], v[60:63]
  s_add_u32 s71, s71, 1
  s_cmp_lt_u32 s71, 2
  s_cbranch_scc1 L_conv_loop1
  s_waitcnt lgkmcnt(0)
  s_lshr_b32 s76, s60, 1
  s_lshl_b32 s76, s76, 2
  s_add_u32 s76, s76, 141336
  v_mov_b32 v21, s76
  s_and_b32 s76, s60, 1
  s_cmp_eq_u32 s76, 0
  s_cbranch_scc1 L_even
  ds_write_b128 v202, v[32:35] offset:0
  ds_write_b128 v202, v[36:39] offset:1024
  ds_write_b128 v202, v[40:43] offset:2048
  ds_write_b128 v202, v[44:47] offset:3072
  ds_write_b128 v202, v[48:51] offset:4096
  ds_write_b128 v202, v[52:55] offset:5120
  ds_write_b128 v202, v[56:59] offset:6144
  ds_write_b128 v202, v[60:63] offset:7168
  v_mov_b32 v20, 1
  s_waitcnt lgkmcnt(0)
  ds_write_b32 v21, v20
  s_waitcnt lgkmcnt(0)
  s_branch L_fin
L_even:
  s_mov_b32 s71, 0
L_hand:
  ds_read_b32 v20, v21
  s_add_u32 s71, s71, 1
  s_cmp_ge_u32 s71, 3200000
  s_waitcnt lgkmcnt(0)
  s_cbranch_scc1 L_handed
  v_cmp_eq_u32 vcc, 0, v20
  s_nop 1
  s_cbranch_vccnz L_hand
L_handed:
  ds_read_b128 v[128:131], v202 offset:17664
  ds_read_b128 v[132:135], v202 offset:18688
  ds_read_b128 v[136:139], v202 offset:19712
  ds_read_b128 v[140:143], v202 offset:20736
  ds_read_b128 v[144:147], v202 offset:21760
  ds_read_b128 v[148:151], v202 offset:22784
  ds_read_b128 v[152:155], v202 offset:23808
  ds_read_b128 v[156:159], v202 offset:24832
  s_waitcnt lgkmcnt(7)
  v_add_f32 v32, v32, v128
  v_add_f32 v33, v33, v129
  v_add_f32 v34, v34, v130
  v_add_f32 v35, v35, v131
  s_waitcnt lgkmcnt(6)
  v_add_f32 v36, v36, v132
  v_add_f32 v37, v37, v133
  v_add_f32 v38, v38, v134
  v_add_f32 v39, v39, v135
  s_waitcnt lgkmcnt(5)
  v_add_f32 v40, v40, v136
  v_add_f32 v41, v41, v137
  v_add_f32 v42, v42, v138
  v_add_f32 v43, v43, v139
  s_waitcnt lgkmcnt(4)
  v_add_f32 v44, v44, v140
  v_add_f32 v45, v45, v141
  v_add_f32 v46, v46, v142
  v_add_f32 v47, v47, v143
  s_waitcnt lgkmcnt(3)
  v_add_f32 v48, v48, v144
  v_add_f32 v49, v49, v145
  v_add_f32 v50, v50, v146
  v_add_f32 v51, v51, v147
  s_waitcnt lgkmcnt(2)
  v_add_f32 v52, v52, v148
  v_add_f32 v53, v53, v149
  v_add_f32 v54, v54, v150
  v_add_f32 v55, v55, v151
  s_waitcnt lgkmcnt(1)
  v_add_f32 v56, v56, v152
  v_add_f32 v57, v57, v153
  v_add_f32 v58, v58, v154
  v_add_f32 v59, v59, v155
  s_waitcnt lgkmcnt(0)
  v_add_f32 v60, v60, v156
  v_add_f32 v61, v61, v157
  v_add_f32 v62, v62, v158
  v_add_f32 v63, v63, v159
  v_cvt_pk_bf16_f32 v96, v32, v33
  v_cvt_pk_bf16_f32 v98, v34, v35
  v_cvt_pk_bf16_f32 v97, v36, v37
  v_cvt_pk_bf16_f32 v99, v38, v39
  v_mov_b32 v22, v97
  v_mov_b32 v23, v99
  v_mov_b32_dpp v97, v96 row_shl:4 row_mask:0xf bank_mask:0x5
  v_mov_b32_dpp v99, v98 row_shl:4 row_mask:0xf bank_mask:0x5
  v_mov_b32_dpp v96, v22 row_shr:4 row_mask:0xf bank_mask:0xa
  v_mov_b32_dpp v98, v23 row_shr:4 row_mask:0xf bank_mask:0xa
  buffer_store_dwordx4 v[96:99], v203, s[36:39], s35 offen offset:0 sc1
  v_cvt_pk_bf16_f32 v100, v40, v41
  v_cvt_pk_bf16_f32 v102, v42, v43
  v_cvt_pk_bf16_f32 v101, v44, v45
  v_cvt_pk_bf16_f32 v103, v46, v47
  v_mov_b32 v22, v101
  v_mov_b32 v23, v103
  v_mov_b32_dpp v101, v100 row_shl:4 row_mask:0xf bank_mask:0x5
  v_mov_b32_dpp v103, v102 row_shl:4 row_mask:0xf bank_mask:0x5
  v_mov_b32_dpp v100, v22 row_shr:4 row_mask:0xf bank_mask:0xa
  v_mov_b32_dpp v102, v23 row_shr:4 row_mask:0xf bank_mask:0xa
  buffer_store_dwordx4 v[100:103], v203, s[36:39], s35 offen offset:1024 sc1
  v_cvt_pk_bf16_f32 v104, v48, v49
  v_cvt_pk_bf16_f32 v106, v50, v51
  v_cvt_pk_bf16_f32 v105, v52, v53
  v_cvt_pk_bf16_f32 v107, v54, v55
  v_mov_b32 v22, v105
  v_mov_b32 v23, v107
  v_mov_b32_dpp v105, v104 row_shl:4 row_mask:0xf bank_mask:0x5
  v_mov_b32_dpp v107, v106 row_shl:4 row_mask:0xf bank_mask:0x5
  v_mov_b32_dpp v104, v22 row_shr:4 row_mask:0xf bank_mask:0xa
  v_mov_b32_dpp v106, v23 row_shr:4 row_mask:0xf bank_mask:0xa
  buffer_store_dwordx4 v[104:107], v203, s[36:39], s35 offen offset:2048 sc1
  v_cvt_pk_bf16_f32 v108, v56, v57
  v_cvt_pk_bf16_f32 v110, v58, v59
  v_cvt_pk_bf16_f32 v109, v60, v61
  v_cvt_pk_bf16_f32 v111, v62, v63
  v_mov_b32 v22, v109
  v_mov_b32 v23, v111
  v_mov_b32_dpp v109, v108 row_shl:4 row_mask:0xf bank_mask:0x5
  v_mov_b32_dpp v111, v110 row_shl:4 row_mask:0xf bank_mask:0x5
  v_mov_b32_dpp v108, v22 row_shr:4 row_mask:0xf bank_mask:0xa
  v_mov_b32_dpp v110, v23 row_shr:4 row_mask:0xf bank_mask:0xa
  buffer_store_dwordx4 v[108:111], v203, s[36:39], s35 offen offset:3072 sc1
  s_lshr_b32 s79, s72, 1
  s_lshl_b32 s79, s79, 7
  s_add_u32 s79, s79, 131072
  v_mov_b32 v24, 141328
  s_waitcnt vmcnt(0)
  v_mov_b32 v25, 1
  s_mov_b64 exec, 1
  ds_add_rtn_u32 v25, v24, v25 offset:0
  s_mov_b64 exec, -1
  s_waitcnt lgkmcnt(0)
  v_readfirstlane_b32 s71, v25
  s_nop 1
  s_cmp_lg_u32 s71, 1
  s_cbranch_scc1 L_notlast_33
  buffer_store_dwordx4 v[196:199], v195, s[36:39], s79 offen sc1
L_notlast_33:
L_fin:
L_end:
  s_endpgm
L_code_end:
.section .rodata,"a"
.p2align 6
.amdhsa_kernel parallel_sum__ssm_conv_h3__swiglu_ffn__prompt_kernel
  .amdhsa_next_free_vgpr 256
  .amdhsa_next_free_sgpr 102
  .amdhsa_accum_offset 256
  .amdhsa_group_segment_fixed_size 0
  .amdhsa_kernarg_size 104
  .amdhsa_user_sgpr_count 2
  .amdhsa_user_sgpr_kernarg_segment_ptr 1
  .amdhsa_system_sgpr_workgroup_id_x 1
  .amdhsa_float_denorm_mode_32 3
.end_amdhsa_kernel
```
